```python
import torch

def _softmax(x, axis=-1):
    return torch.softmax(x, dim=axis)
def _gelu(x):
    return torch.nn.functional.gelu(x, approximate="tanh")
def _silu(x):
    return torch.nn.functional.silu(x)
def _sigmoid(x):
    return torch.sigmoid(x)
def _layernorm(x, axis=-1, eps=1e-5):
    m = x.mean(dim=axis, keepdim=True)
    v = x.var(dim=axis, keepdim=True, unbiased=False)
    return (x - m) / torch.sqrt(v + eps)
def _scatter_add(tgt, idx, src, axis=0):
    return tgt.clone().index_add_(axis, idx, src)
def _segment_sum(src, seg, n):
    out = torch.zeros((n,) + src.shape[1:], dtype=src.dtype)
    return out.index_add_(0, seg, src)
def _pad(x, pw):
    flat = tuple(v for pair in reversed(pw) for v in pair)
    return torch.nn.functional.pad(x, flat)

kernel_name = 'sequential_preLN__gqa_block_cached__glu_gated_reglu__decode'

def setup_inputs():

    _w = (lambda a: (lambda t: t.to(torch.bfloat16) if t.is_floating_point() else t)(torch.as_tensor(a)))
    def _A_setup():
        B, Sq, D = 1, 1, 512
        Hq, Hkv, Sk, Dh = 32, 8, 65536, 128
        assert Hq % Hkv == 0, (Hq, Hkv)
        return {
            "x": _w((lambda *s: torch.randn(*s, dtype=torch.bfloat16) * 0.05)(B, Sq, D)),
            "k_cache": _w((lambda *s: torch.randn(*s, dtype=torch.bfloat16) * 3.2)(B, Hkv, Sk, Dh)),
            "v_cache": _w((lambda *s: torch.randn(*s, dtype=torch.bfloat16) * 1.6)(B, Hkv, Sk, Dh)),
            "wq": _w((lambda *s: torch.randn(*s, dtype=torch.bfloat16) * 3.2)(D, Hq * Dh) * (D ** -0.5)),
            "wo": _w((lambda *s: torch.randn(*s, dtype=torch.bfloat16) * 1.6)(Hq * Dh, D) * ((Hq * Dh) ** -0.5)),
        }
    _A_in = _A_setup()

    def _B_setup():
        B, S, D, F = 1, 1, 512, 1792
        return {
            "x": _w((lambda *s: torch.randn(*s, dtype=torch.bfloat16) * 0.05)(B, S, D)),
            "W_gate": _w((lambda *s: torch.randn(*s, dtype=torch.bfloat16) * 1.6)(D, F) * (2.0 / D) ** 0.5),
            "W_up": _w((lambda *s: torch.randn(*s, dtype=torch.bfloat16) * 1.6)(D, F) * (2.0 / D) ** 0.5),
            "W_down": _w((lambda *s: torch.randn(*s, dtype=torch.bfloat16) * 1.6)(F, D) * (1.0 / F) ** 0.5),
        }
    _B_in = _B_setup()

    return {
        "A_x": _A_in["x"],
        "A_k_cache": _A_in["k_cache"],
        "A_v_cache": _A_in["v_cache"],
        "A_wq": _A_in["wq"],
        "A_wo": _A_in["wo"],
        "B_x": _B_in["x"],
        "B_W_gate": _B_in["W_gate"],
        "B_W_up": _B_in["W_up"],
        "B_W_down": _B_in["W_down"],
    }

def reference(A_x, A_k_cache, A_v_cache, A_wq, A_wo, B_x, B_W_gate, B_W_up, B_W_down):
    def _A_ref(x, k_cache, v_cache, wq, wo):
        B, Sq, D = x.shape
        Hq, Dh = 32, 128
        Hkv = k_cache.shape[1]
        rep = Hq // Hkv
        q = (lambda x, *d: x.permute(*d))((x @ wq).reshape(B, Sq, Hq, Dh), 0, 2, 1, 3)
        k = (lambda x, n, axis: torch.repeat_interleave(x, n, dim=axis))(k_cache, rep, axis=1)
        v = (lambda x, n, axis: torch.repeat_interleave(x, n, dim=axis))(v_cache, rep, axis=1)
        scores = torch.einsum("bhqd,bhkd->bhqk", q, k) * (Dh ** -0.5)
        p = _softmax(scores, axis=-1)
        o = torch.einsum("bhqk,bhkd->bhqd", p, v)
        return (lambda x, *d: x.permute(*d))(o, 0, 2, 1, 3).reshape(B, Sq, Hq * Dh) @ wo

    def _B_ref(x, W_gate, W_up, W_down):
        gate = torch.einsum("bsd,df->bsf", x, W_gate)
        up = torch.einsum("bsd,df->bsf", x, W_up)
        gate = gate * (lambda x, dt: x.to(dt))(gate > 0, gate.dtype)
        h = gate * up
        return torch.einsum("bsf,fd->bsd", h, W_down)

    x = A_x
    h = x + _A_ref(_layernorm(x, axis=-1), A_k_cache, A_v_cache, A_wq, A_wo)
    h2 = h + _B_ref(_layernorm(h, axis=-1), B_W_gate, B_W_up, B_W_down)
    return h2
```

```asm
; @launch grid=(256,1,1) block=(256,1,1) lds=14336
.amdgcn_target "amdgcn-amd-amdhsa--gfx950"
.text
.globl sequential_preLN__gqa_block_cached__glu_gated_reglu__decode_kernel
.p2align 8
.type sequential_preLN__gqa_block_cached__glu_gated_reglu__decode_kernel,@function
sequential_preLN__gqa_block_cached__glu_gated_reglu__decode_kernel:
  s_cmp_ge_u32 s2, 256
  s_cbranch_scc1 L_end
  s_load_dwordx16 s[4:19], s[0:1], 0
  s_load_dwordx8 s[20:27], s[0:1], 64
  v_lshrrev_b32 v5, 6, v0
  v_and_b32 v1, 63, v0
  v_readfirstlane_b32 s52, v5
  s_lshr_b32 s53, s2, 5
  s_and_b32 s54, s2, 31
  s_and_b32 s60, s2, 7
  s_bfe_u32 s61, s2, 0x20003
  s_mov_b32 s62, 0x05040100
  s_mov_b32 s63, 0x07060302
  s_mov_b32 s70, 0xffffff00
  s_mov_b32 s73, 0x3fb8aa3b
  v_lshlrev_b32 v3, 4, v0
  v_lshrrev_b32 v6, 4, v1
  v_lshlrev_b32 v6, 6, v6
  v_bfe_u32 v7, v1, 2, 2
  v_lshlrev_b32 v7, 8, v7
  v_and_b32 v2, 3, v1
  v_lshlrev_b32 v2, 4, v2
  v_add3_u32 v2, v2, v6, v7
  v_lshlrev_b32 v5, 10, v5
  v_add_u32 v2, v2, v5
  v_lshlrev_b32 v211, 4, v1
  v_lshrrev_b32 v72, 2, v0
  v_lshlrev_b32 v6, 4, v72
  s_lshl_b32 s59, s60, 1
  s_and_b32 s65, s61, 1
  s_add_u32 s59, s59, s65
  s_lshl_b32 s59, s59, 6
  s_lshl_b32 s65, s53, 10
  s_add_u32 s64, s59, s65
  v_lshlrev_b32 v72, 16, v72
  v_and_b32 v73, 48, v211
  v_add3_u32 v7, v72, v73, s64
  s_lshl_b32 s59, s53, 1
  s_add_u32 s59, s59, s61
  s_sub_u32 s59, s59, 1
  s_mul_i32 s66, s60, 14
  s_add_u32 s66, s66, s59
  s_cmp_lt_u32 s59, 14
  s_cselect_b32 s55, 1, 3
  s_lshl_b32 s59, s60, 3
  s_add_u32 s59, s59, s53
  s_cmp_eq_u32 s61, 0
  s_cselect_b32 s55, 0, s55
  s_cselect_b32 s66, s59, s66
  s_cmp_eq_u32 s61, 3
  s_cselect_b32 s55, 2, s55
  s_cselect_b32 s66, s59, s66
  s_sub_u32 s59, s52, s2
  s_and_b32 s59, s59, 3
  s_cmp_eq_u32 s59, 0
  s_cselect_b32 s74, 1, 0
  s_sub_u32 s77, s61, s60
  s_and_b32 s77, s77, 3
  s_lshl_b32 s59, s53, 2
  s_add_u32 s59, s59, s77
  s_lshl_b32 s59, s59, 2
  s_add_u32 s59, s59, s52
  s_mul_i32 s59, s59, 4352
  s_add_u32 s59, s59, 4194304
  v_mul_u32_u24 v201, 17408, v1
  v_add_u32 v201, s59, v201
  v_mov_b32 v202, 1
  v_mov_b32 v23, 0
  v_lshlrev_b32 v203, 2, v0
  s_lshl_b32 s59, s53, 24
  s_lshl_b32 s57, s54, 19
  s_waitcnt lgkmcnt(0)
  s_load_dword s56, s[26:27], 0
  s_add_u32 s28, s6, s59
  s_addc_u32 s29, s7, 0
  s_mov_b32 s30, 0x1000000
  s_mov_b32 s31, 0x20000
  s_add_u32 s32, s8, s59
  s_addc_u32 s33, s9, 0
  s_mov_b32 s34, 0x1000000
  s_mov_b32 s35, 0x20000
  s_mov_b32 s48, s26
  s_mov_b32 s49, s27
  s_mov_b32 s50, 0x0
  s_mov_b32 s51, 0x20000
  s_bitcmp1_b32 s55, 0
  s_cbranch_scc1 L_gu
  s_cmp_lg_u32 s54, 0
  s_cbranch_scc1 L_noclr
  s_mov_b64 exec, 15
  global_store_dword v201, v23, s[26:27] sc0 sc1
  s_mov_b64 exec, -1
L_noclr:
  global_load_dwordx4 v[228:231], v211, s[4:5]
  global_load_dwordx4 v[232:235], v6, s[4:5]
  s_mov_b32 s40, s10
  s_mov_b32 s41, s11
  s_mov_b32 s42, 0x400000
  s_mov_b32 s43, 0x20000
  buffer_load_dwordx4 v[152:155], v7, s[40:43], 0 offen nt
  s_mov_b32 s65, 8192
  buffer_load_dwordx4 v[156:159], v7, s[40:43], s65 offen nt
  s_mov_b32 s65, 16384
  buffer_load_dwordx4 v[160:163], v7, s[40:43], s65 offen nt
  s_mov_b32 s65, 24576
  buffer_load_dwordx4 v[164:167], v7, s[40:43], s65 offen nt
  s_mov_b32 s65, 32768
  buffer_load_dwordx4 v[168:171], v7, s[40:43], s65 offen nt
  s_mov_b32 s65, 40960
  buffer_load_dwordx4 v[172:175], v7, s[40:43], s65 offen nt
  s_mov_b32 s65, 49152
  buffer_load_dwordx4 v[176:179], v7, s[40:43], s65 offen nt
  s_mov_b32 s65, 57344
  buffer_load_dwordx4 v[180:183], v7, s[40:43], s65 offen nt
  s_branch L_wodone
L_gu:
  s_add_u32 s59, s57, 0
  buffer_load_dwordx4 a[0:3], v2, s[28:31], s59 offen nt
  s_add_u32 s59, s57, 4096
  buffer_load_dwordx4 a[4:7], v2, s[28:31], s59 offen nt
  s_add_u32 s59, s57, 8192
  buffer_load_dwordx4 a[8:11], v2, s[28:31], s59 offen nt
  s_add_u32 s59, s57, 12288
  buffer_load_dwordx4 a[12:15], v2, s[28:31], s59 offen nt
  s_add_u32 s59, s57, 16384
  buffer_load_dwordx4 a[16:19], v2, s[28:31], s59 offen nt
  s_add_u32 s59, s57, 20480
  buffer_load_dwordx4 a[20:23], v2, s[28:31], s59 offen nt
  s_add_u32 s59, s57, 24576
  buffer_load_dwordx4 a[24:27], v2, s[28:31], s59 offen nt
  s_add_u32 s59, s57, 28672
  buffer_load_dwordx4 a[28:31], v2, s[28:31], s59 offen nt
  v_mov_b32 v23, 1
  s_mov_b64 exec, 1
  buffer_atomic_add v23, v201, s[48:51], 0 offen sc0 sc1
  s_mov_b64 exec, -1
  s_add_u32 s59, s57, 0
  buffer_load_dwordx4 a[32:35], v3, s[32:35], s59 offen nt
  s_add_u32 s59, s57, 4096
  buffer_load_dwordx4 a[36:39], v3, s[32:35], s59 offen nt
  s_add_u32 s59, s57, 8192
  buffer_load_dwordx4 a[40:43], v3, s[32:35], s59 offen nt
  s_add_u32 s59, s57, 12288
  buffer_load_dwordx4 a[44:47], v3, s[32:35], s59 offen nt
  s_add_u32 s59, s57, 16384
  buffer_load_dwordx4 a[48:51], v3, s[32:35], s59 offen nt
  s_add_u32 s59, s57, 20480
  buffer_load_dwordx4 a[52:55], v3, s[32:35], s59 offen nt
  s_add_u32 s59, s57, 24576
  buffer_load_dwordx4 a[56:59], v3, s[32:35], s59 offen nt
  s_add_u32 s59, s57, 28672
  buffer_load_dwordx4 a[60:63], v3, s[32:35], s59 offen nt
L_wodone:
  s_mov_b32 s36, s26
  s_mov_b32 s37, s27
  s_mov_b32 s38, 0x800000
  s_mov_b32 s39, 0x20000
  v_mov_b32 v72, 0
  v_mov_b32 v73, 0
  ds_write_b64 v72, v[72:73] offset:1024
  v_and_b32 v6, 3, v1
  v_lshlrev_b32 v6, 5, v6
  v_lshrrev_b32 v7, 4, v1
  v_lshlrev_b32 v7, 3, v7
  s_lshl_b32 s64, s64, 1
  s_add_u32 s64, s64, 16384
  v_add3_u32 v6, v6, v7, s64
  v_and_b32 v5, 3, v1
  v_lshlrev_b32 v5, 9, v5
  v_lshrrev_b32 v7, 2, v1
  v_lshlrev_b32 v7, 5, v7
  s_lshl_b32 s59, s53, 11
  s_add_u32 s59, s59, 16384
  v_add3_u32 v5, v5, v7, s59
  v_lshlrev_b32 v7, 2, v1
  v_mov_b32 v40, 0
  v_mov_b32 v41, 0
  v_mov_b32 v42, 0
  v_mov_b32 v43, 0
  v_mov_b32 v44, 0
  v_mov_b32 v45, 0
  v_mov_b32 v46, 0
  v_mov_b32 v47, 0
  v_mov_b32 v12, 0
  v_mov_b32 v13, 0
  v_mov_b32 v14, 0
  v_mov_b32 v15, 0
  v_mov_b32 v16, 0
  v_mov_b32 v17, 0
  v_mov_b32 v18, 0
  v_mov_b32 v19, 0
  v_mov_b32 v24, 0
  v_mov_b32 v25, 0
  v_mov_b32 v26, 0
  v_mov_b32 v27, 0
  v_mov_b32 v28, 0
  v_mov_b32 v29, 0
  v_mov_b32 v30, 0
  v_mov_b32 v31, 0
  v_mov_b32 v32, 0
  v_mov_b32 v33, 0
  v_mov_b32 v34, 0
  v_mov_b32 v35, 0
  v_mov_b32 v36, 0
  v_mov_b32 v37, 0
  v_mov_b32 v38, 0
  v_mov_b32 v39, 0
  v_mov_b32 v22, 0xff800000
  v_mov_b32 v21, 0
  v_mov_b32 v20, 0
  v_mov_b32 v4, 0
  s_mov_b32 s58, 0
  s_mov_b32 s67, 0
  s_bitcmp1_b32 s55, 0
  s_cbranch_scc1 L_noq
  s_waitcnt vmcnt(8)
  v_lshlrev_b32 v236, 16, v228
  v_and_b32 v237, 0xffff0000, v228
  v_lshlrev_b32 v238, 16, v229
  v_and_b32 v239, 0xffff0000, v229
  v_lshlrev_b32 v240, 16, v230
  v_and_b32 v241, 0xffff0000, v230
  v_lshlrev_b32 v242, 16, v231
  v_and_b32 v243, 0xffff0000, v231
  v_add_f32 v80, v236, v237
  v_mul_f32 v81, v236, v236
  v_add_f32 v82, v238, v239
  v_mul_f32 v83, v237, v237
  v_fmac_f32 v81, v238, v238
  v_fmac_f32 v83, v239, v239
  v_fmac_f32 v81, v240, v240
  v_add_f32 v80, v80, v240
  v_fmac_f32 v83, v241, v241
  v_add_f32 v82, v82, v241
  v_fmac_f32 v81, v242, v242
  v_add_f32 v80, v80, v242
  v_fmac_f32 v83, v243, v243
  v_add_f32 v82, v82, v243
  v_add_f32 v80, v80, v82
  v_add_f32 v81, v81, v83
  v_lshlrev_b32 v236, 16, v232
  v_and_b32 v237, 0xffff0000, v232
  v_lshlrev_b32 v238, 16, v233
  v_and_b32 v239, 0xffff0000, v233
  v_lshlrev_b32 v240, 16, v234
  v_and_b32 v241, 0xffff0000, v234
  v_lshlrev_b32 v242, 16, v235
  v_and_b32 v243, 0xffff0000, v235
  v_permlane32_swap_b32 v80, v81
  v_add_f32 v80, v80, v81
  s_nop 1
  v_add_f32_dpp v80, v80, v80 quad_perm:[1,0,3,2] row_mask:0xf bank_mask:0xf
  s_nop 1
  v_add_f32_dpp v80, v80, v80 quad_perm:[2,3,0,1] row_mask:0xf bank_mask:0xf
  s_nop 1
  v_add_f32_dpp v80, v80, v80 row_half_mirror row_mask:0xf bank_mask:0xf
  s_nop 1
  v_add_f32_dpp v80, v80, v80 row_mirror row_mask:0xf bank_mask:0xf
  v_mov_b32 v82, v80
  s_nop 1
  v_permlane16_swap_b32 v80, v82
  v_add_f32 v80, v80, v82
  v_mul_f32 v80, 0x3b000000, v80
  v_mov_b32 v81, v80
  s_nop 1
  v_permlane32_swap_b32 v80, v81
  v_fma_f32 v81, -v80, v80, v81
  v_max_f32 v81, 0, v81
  v_cvt_pk_bf16_f32 v82, v80, v81
  v_and_b32 v81, 0xffff0000, v82
  v_add_f32 v81, 0x3727c5ac, v81
  v_lshlrev_b32 v84, 16, v82
  v_cvt_pk_bf16_f32 v81, v81, v81
  v_lshlrev_b32 v81, 16, v81
  v_sqrt_f32 v81, v81
  v_sub_f32 v236, v236, v84
  v_sub_f32 v237, v237, v84
  v_cvt_pk_bf16_f32 v81, v81, v81
  v_lshlrev_b32 v81, 16, v81
  v_rcp_f32 v85, v81
  v_sub_f32 v238, v238, v84
  v_sub_f32 v239, v239, v84
  v_sub_f32 v240, v240, v84
  v_sub_f32 v241, v241, v84
  v_sub_f32 v242, v242, v84
  v_sub_f32 v243, v243, v84
  v_cvt_pk_bf16_f32 v232, v236, v237
  v_cvt_pk_bf16_f32 v233, v238, v239
  v_cvt_pk_bf16_f32 v234, v240, v241
  v_cvt_pk_bf16_f32 v235, v242, v243
  v_lshlrev_b32 v236, 16, v232
  v_and_b32 v237, 0xffff0000, v232
  v_lshlrev_b32 v238, 16, v233
  v_and_b32 v239, 0xffff0000, v233
  v_lshlrev_b32 v240, 16, v234
  v_and_b32 v241, 0xffff0000, v234
  v_lshlrev_b32 v242, 16, v235
  v_and_b32 v243, 0xffff0000, v235
  v_mul_f32 v236, v236, v85
  v_mul_f32 v237, v237, v85
  v_mul_f32 v238, v238, v85
  v_mul_f32 v239, v239, v85
  v_mul_f32 v240, v240, v85
  v_mul_f32 v241, v241, v85
  v_mul_f32 v242, v242, v85
  v_mul_f32 v243, v243, v85
  v_cvt_pk_bf16_f32 v232, v236, v237
  v_cvt_pk_bf16_f32 v233, v238, v239
  v_cvt_pk_bf16_f32 v234, v240, v241
  v_cvt_pk_bf16_f32 v235, v242, v243
  s_waitcnt vmcnt(6)
  v_perm_b32 v72, v156, v152, s62
  v_perm_b32 v73, v156, v152, s63
  v_perm_b32 v74, v157, v153, s62
  v_perm_b32 v75, v157, v153, s63
  v_perm_b32 v76, v158, v154, s62
  v_perm_b32 v77, v158, v154, s63
  v_perm_b32 v78, v159, v155, s62
  v_perm_b32 v79, v159, v155, s63
  v_dot2c_f32_bf16 v40, v72, v232
  v_dot2c_f32_bf16 v41, v73, v232
  v_dot2c_f32_bf16 v42, v74, v232
  v_dot2c_f32_bf16 v43, v75, v232
  v_dot2c_f32_bf16 v44, v76, v232
  v_dot2c_f32_bf16 v45, v77, v232
  v_dot2c_f32_bf16 v46, v78, v232
  v_dot2c_f32_bf16 v47, v79, v232
  s_waitcnt vmcnt(4)
  v_perm_b32 v72, v164, v160, s62
  v_perm_b32 v73, v164, v160, s63
  v_perm_b32 v74, v165, v161, s62
  v_perm_b32 v75, v165, v161, s63
  v_perm_b32 v76, v166, v162, s62
  v_perm_b32 v77, v166, v162, s63
  v_perm_b32 v78, v167, v163, s62
  v_perm_b32 v79, v167, v163, s63
  v_dot2c_f32_bf16 v40, v72, v233
  v_dot2c_f32_bf16 v41, v73, v233
  v_dot2c_f32_bf16 v42, v74, v233
  v_dot2c_f32_bf16 v43, v75, v233
  v_dot2c_f32_bf16 v44, v76, v233
  v_dot2c_f32_bf16 v45, v77, v233
  v_dot2c_f32_bf16 v46, v78, v233
  v_dot2c_f32_bf16 v47, v79, v233
  s_waitcnt vmcnt(2)
  v_perm_b32 v72, v172, v168, s62
  v_perm_b32 v73, v172, v168, s63
  v_perm_b32 v74, v173, v169, s62
  v_perm_b32 v75, v173, v169, s63
  v_perm_b32 v76, v174, v170, s62
  v_perm_b32 v77, v174, v170, s63
  v_perm_b32 v78, v175, v171, s62
  v_perm_b32 v79, v175, v171, s63
  v_dot2c_f32_bf16 v40, v72, v234
  v_dot2c_f32_bf16 v41, v73, v234
  v_dot2c_f32_bf16 v42, v74, v234
  v_dot2c_f32_bf16 v43, v75, v234
  v_dot2c_f32_bf16 v44, v76, v234
  v_dot2c_f32_bf16 v45, v77, v234
  v_dot2c_f32_bf16 v46, v78, v234
  v_dot2c_f32_bf16 v47, v79, v234
  s_waitcnt vmcnt(0)
  v_perm_b32 v72, v180, v176, s62
  v_perm_b32 v73, v180, v176, s63
  v_perm_b32 v74, v181, v177, s62
  v_perm_b32 v75, v181, v177, s63
  v_perm_b32 v76, v182, v178, s62
  v_perm_b32 v77, v182, v178, s63
  v_perm_b32 v78, v183, v179, s62
  v_perm_b32 v79, v183, v179, s63
  v_dot2c_f32_bf16 v40, v72, v235
  v_dot2c_f32_bf16 v41, v73, v235
  v_dot2c_f32_bf16 v42, v74, v235
  v_dot2c_f32_bf16 v43, v75, v235
  v_dot2c_f32_bf16 v44, v76, v235
  v_dot2c_f32_bf16 v45, v77, v235
  v_dot2c_f32_bf16 v46, v78, v235
  v_dot2c_f32_bf16 v47, v79, v235
  v_permlane32_swap_b32 v40, v44
  v_permlane32_swap_b32 v41, v45
  v_permlane32_swap_b32 v42, v46
  v_permlane32_swap_b32 v43, v47
  v_add_f32 v40, v40, v44
  v_add_f32 v41, v41, v45
  v_add_f32 v42, v42, v46
  v_add_f32 v43, v43, v47
  s_nop 0
  v_permlane16_swap_b32 v40, v42
  v_permlane16_swap_b32 v41, v43
  v_add_f32 v40, v40, v42
  v_add_f32 v41, v41, v43
  s_nop 0
  v_add_f32_dpp v40, v40, v40 row_ror:12 row_mask:0xf bank_mask:0x5
  s_nop 1
  v_add_f32_dpp v40, v41, v41 row_ror:4 row_mask:0xf bank_mask:0xa
  s_nop 1
  v_add_f32_dpp v40, v40, v40 row_ror:8 row_mask:0xf bank_mask:0xf
  ds_write_b32 v203, v40 offset:0
L_noq:
  s_waitcnt lgkmcnt(0)
  s_mul_i32 s56, s56, 0x9e3779b1
  s_add_u32 s56, s56, 0x7f4a7c15
  s_barrier
  s_cmp_eq_u32 s74, 0
  s_cbranch_scc1 L_pre
  s_bitcmp1_b32 s55, 0
  s_cbranch_scc1 L_nopub
  ds_read2st64_b32 v[72:73], v7 offset0:0 offset1:1
  ds_read2st64_b32 v[74:75], v7 offset0:2 offset1:3
  v_mov_b32 v77, s56
  s_waitcnt lgkmcnt(0)
  v_add_f32 v72, v72, v73
  v_add_f32 v74, v74, v75
  v_add_f32 v72, v72, v74
  s_nop 1
  v_mov_b32_dpp v73, v72 row_ror:12 row_mask:0xf bank_mask:0xf
  v_cvt_pk_bf16_f32 v76, v72, v73
  s_mov_b32 exec_lo, 0x000f000f
  s_mov_b32 exec_hi, 0x000f000f
  buffer_store_dwordx2 v[76:77], v6, s[36:39], 0 offen sc1
  s_mov_b64 exec, -1
  s_branch L_pubd
L_nopub:
  s_sleep 90
L_pubd:
  v_mov_b32 v72, s56
  v_bfe_u32 v205, v72, 0, 8
  v_bfe_u32 v206, v72, 8, 8
  v_bfe_u32 v207, v72, 16, 8
  v_bfe_u32 v208, v72, 24, 8
  v_and_b32 v73, 1, v1
  v_lshlrev_b32 v73, 4, v73
  v_lshrrev_b32 v72, v73, v72
  v_and_b32 v209, 0xff, v72
  v_bfe_u32 v210, v72, 8, 8
  s_mov_b32 s64, 200000
L_hQ:
  buffer_load_dwordx4 v[244:247], v5, s[36:39], 0 offen sc1
  buffer_load_dwordx4 v[248:251], v5, s[36:39], 0 offen offset:16 sc1
  s_waitcnt vmcnt(0)
  v_xor_b32 v72, s56, v245
  v_bitop3_b32 v72, v72, v247, s56 bitop3:0xf6
  v_bitop3_b32 v72, v72, v249, s56 bitop3:0xf6
  v_bitop3_b32 v72, v72, v251, s56 bitop3:0xf6
  v_cmp_ne_u32 vcc, 0, v72
  s_cbranch_vccz L_hQ_ok
  s_mov_b64 exec, vcc
  s_sub_u32 s64, s64, 1
  s_cmp_lg_u32 s64, 0
  s_cbranch_scc1 L_hQ
L_hQ_ok:
  s_mov_b64 exec, -1
  v_mov_b32 v8, v244
  v_mov_b32 v9, v246
  v_mov_b32 v10, v248
  v_mov_b32 v11, v250
  ds_write_b128 v211, v[8:11] offset:2048
  ds_write_b32 v4, v202 offset:1028
  s_mov_b32 s68, 0
  s_mov_b32 s69, 0
  s_bitcmp1_b32 s55, 0
  s_cbranch_scc1 L_qdone
  s_add_u32 s59, s57, 0
  buffer_load_dwordx4 a[0:3], v2, s[28:31], s59 offen nt
  s_add_u32 s59, s57, 4096
  buffer_load_dwordx4 a[4:7], v2, s[28:31], s59 offen nt
  s_add_u32 s59, s57, 8192
  buffer_load_dwordx4 a[8:11], v2, s[28:31], s59 offen nt
  s_add_u32 s59, s57, 12288
  buffer_load_dwordx4 a[12:15], v2, s[28:31], s59 offen nt
  s_add_u32 s59, s57, 16384
  buffer_load_dwordx4 a[16:19], v2, s[28:31], s59 offen nt
  s_add_u32 s59, s57, 20480
  buffer_load_dwordx4 a[20:23], v2, s[28:31], s59 offen nt
  s_add_u32 s59, s57, 24576
  buffer_load_dwordx4 a[24:27], v2, s[28:31], s59 offen nt
  s_add_u32 s59, s57, 28672
  buffer_load_dwordx4 a[28:31], v2, s[28:31], s59 offen nt
  v_mov_b32 v23, 1
  s_mov_b64 exec, 1
  buffer_atomic_add v23, v201, s[48:51], 0 offen sc0 sc1
  s_mov_b64 exec, -1
  s_add_u32 s59, s57, 0
  buffer_load_dwordx4 a[32:35], v3, s[32:35], s59 offen nt
  s_add_u32 s59, s57, 4096
  buffer_load_dwordx4 a[36:39], v3, s[32:35], s59 offen nt
  s_add_u32 s59, s57, 8192
  buffer_load_dwordx4 a[40:43], v3, s[32:35], s59 offen nt
  s_add_u32 s59, s57, 12288
  buffer_load_dwordx4 a[44:47], v3, s[32:35], s59 offen nt
  s_add_u32 s59, s57, 16384
  buffer_load_dwordx4 a[48:51], v3, s[32:35], s59 offen nt
  s_add_u32 s59, s57, 20480
  buffer_load_dwordx4 a[52:55], v3, s[32:35], s59 offen nt
  s_add_u32 s59, s57, 24576
  buffer_load_dwordx4 a[56:59], v3, s[32:35], s59 offen nt
  s_add_u32 s59, s57, 28672
  buffer_load_dwordx4 a[60:63], v3, s[32:35], s59 offen nt
  s_branch L_qdone
L_pre:
  v_mov_b32 v72, s56
  v_bfe_u32 v205, v72, 0, 8
  v_bfe_u32 v206, v72, 8, 8
  v_bfe_u32 v207, v72, 16, 8
  v_bfe_u32 v208, v72, 24, 8
  v_and_b32 v73, 1, v1
  v_lshlrev_b32 v73, 4, v73
  v_lshrrev_b32 v72, v73, v72
  v_and_b32 v209, 0xff, v72
  v_bfe_u32 v210, v72, 8, 8
  s_bitcmp1_b32 s55, 0
  s_cbranch_scc1 L_pre1
  s_add_u32 s59, s57, 0
  buffer_load_dwordx4 a[0:3], v2, s[28:31], s59 offen nt
  s_add_u32 s59, s57, 4096
  buffer_load_dwordx4 a[4:7], v2, s[28:31], s59 offen nt
  s_add_u32 s59, s57, 8192
  buffer_load_dwordx4 a[8:11], v2, s[28:31], s59 offen nt
  s_add_u32 s59, s57, 12288
  buffer_load_dwordx4 a[12:15], v2, s[28:31], s59 offen nt
  s_add_u32 s59, s57, 16384
  buffer_load_dwordx4 a[16:19], v2, s[28:31], s59 offen nt
  s_add_u32 s59, s57, 20480
  buffer_load_dwordx4 a[20:23], v2, s[28:31], s59 offen nt
  s_add_u32 s59, s57, 24576
  buffer_load_dwordx4 a[24:27], v2, s[28:31], s59 offen nt
  s_add_u32 s59, s57, 28672
  buffer_load_dwordx4 a[28:31], v2, s[28:31], s59 offen nt
  s_waitcnt vmcnt(7)
  v_mov_b32 v23, 1
  s_mov_b64 exec, 1
  buffer_atomic_add v23, v201, s[48:51], 0 offen sc0 sc1
  s_mov_b64 exec, -1
  s_waitcnt vmcnt(7)
  s_add_u32 s59, s57, 0
  buffer_load_dwordx4 a[32:35], v3, s[32:35], s59 offen nt
  s_waitcnt vmcnt(7)
  s_add_u32 s59, s57, 4096
  buffer_load_dwordx4 a[36:39], v3, s[32:35], s59 offen nt
  s_waitcnt vmcnt(7)
  s_add_u32 s59, s57, 8192
  buffer_load_dwordx4 a[40:43], v3, s[32:35], s59 offen nt
  s_waitcnt vmcnt(7)
  s_add_u32 s59, s57, 12288
  buffer_load_dwordx4 a[44:47], v3, s[32:35], s59 offen nt
  s_waitcnt vmcnt(7)
  s_add_u32 s59, s57, 16384
  buffer_load_dwordx4 a[48:51], v3, s[32:35], s59 offen nt
  s_waitcnt vmcnt(7)
  s_add_u32 s59, s57, 20480
  buffer_load_dwordx4 a[52:55], v3, s[32:35], s59 offen nt
  s_waitcnt vmcnt(7)
  s_add_u32 s59, s57, 24576
  buffer_load_dwordx4 a[56:59], v3, s[32:35], s59 offen nt
  s_waitcnt vmcnt(7)
  s_add_u32 s59, s57, 28672
  buffer_load_dwordx4 a[60:63], v3, s[32:35], s59 offen nt
  s_mov_b32 s68, 1
  s_mov_b32 s69, 0
  ds_read_b32 v204, v4 offset:1028
  ds_read_b128 v[8:11], v211 offset:2048
  s_waitcnt lgkmcnt(0)
  v_cmp_ne_u32 vcc, 0, v204
  s_cbranch_vccnz L_qdone
L_pre1:
  s_waitcnt vmcnt(7)
  s_add_u32 s59, s57, 32768
  buffer_load_dwordx4 a[64:67], v2, s[28:31], s59 offen nt
  s_waitcnt vmcnt(7)
  s_add_u32 s59, s57, 36864
  buffer_load_dwordx4 a[68:71], v2, s[28:31], s59 offen nt
  s_waitcnt vmcnt(7)
  s_add_u32 s59, s57, 40960
  buffer_load_dwordx4 a[72:75], v2, s[28:31], s59 offen nt
  s_waitcnt vmcnt(7)
  s_add_u32 s59, s57, 45056
  buffer_load_dwordx4 a[76:79], v2, s[28:31], s59 offen nt
  s_waitcnt vmcnt(7)
  s_add_u32 s59, s57, 49152
  buffer_load_dwordx4 a[80:83], v2, s[28:31], s59 offen nt
  s_waitcnt vmcnt(7)
  s_add_u32 s59, s57, 53248
  buffer_load_dwordx4 a[84:87], v2, s[28:31], s59 offen nt
  s_waitcnt vmcnt(7)
  s_add_u32 s59, s57, 57344
  buffer_load_dwordx4 a[88:91], v2, s[28:31], s59 offen nt
  s_waitcnt vmcnt(7)
  s_add_u32 s59, s57, 61440
  buffer_load_dwordx4 a[92:95], v2, s[28:31], s59 offen nt
  s_mov_b32 s68, 2
  s_mov_b32 s69, 1
  ds_read_b32 v204, v4 offset:1028
  ds_read_b128 v[8:11], v211 offset:2048
  s_waitcnt lgkmcnt(0)
  v_cmp_ne_u32 vcc, 0, v204
  s_cbranch_vccnz L_qdone
  s_waitcnt vmcnt(7)
  v_mov_b32 v23, 1
  s_mov_b64 exec, 1
  buffer_atomic_add v23, v201, s[48:51], 0 offen sc0 sc1
  s_mov_b64 exec, -1
  s_waitcnt vmcnt(7)
  s_add_u32 s59, s57, 32768
  buffer_load_dwordx4 a[96:99], v3, s[32:35], s59 offen nt
  s_waitcnt vmcnt(7)
  s_add_u32 s59, s57, 36864
  buffer_load_dwordx4 a[100:103], v3, s[32:35], s59 offen nt
  s_waitcnt vmcnt(7)
  s_add_u32 s59, s57, 40960
  buffer_load_dwordx4 a[104:107], v3, s[32:35], s59 offen nt
  s_waitcnt vmcnt(7)
  s_add_u32 s59, s57, 45056
  buffer_load_dwordx4 a[108:111], v3, s[32:35], s59 offen nt
  s_waitcnt vmcnt(7)
  s_add_u32 s59, s57, 49152
  buffer_load_dwordx4 a[112:115], v3, s[32:35], s59 offen nt
  s_waitcnt vmcnt(7)
  s_add_u32 s59, s57, 53248
  buffer_load_dwordx4 a[116:119], v3, s[32:35], s59 offen nt
  s_waitcnt vmcnt(7)
  s_add_u32 s59, s57, 57344
  buffer_load_dwordx4 a[120:123], v3, s[32:35], s59 offen nt
  s_waitcnt vmcnt(7)
  s_add_u32 s59, s57, 61440
  buffer_load_dwordx4 a[124:127], v3, s[32:35], s59 offen nt
  s_mov_b32 s68, 3
  s_mov_b32 s69, 2
  ds_read_b32 v204, v4 offset:1028
  ds_read_b128 v[8:11], v211 offset:2048
  s_waitcnt lgkmcnt(0)
  v_cmp_ne_u32 vcc, 0, v204
  s_cbranch_vccnz L_qdone
  s_waitcnt vmcnt(7)
  s_add_u32 s59, s57, 65536
  buffer_load_dwordx4 a[128:131], v2, s[28:31], s59 offen nt
  s_waitcnt vmcnt(7)
  s_add_u32 s59, s57, 69632
  buffer_load_dwordx4 a[132:135], v2, s[28:31], s59 offen nt
  s_waitcnt vmcnt(7)
  s_add_u32 s59, s57, 73728
  buffer_load_dwordx4 a[136:139], v2, s[28:31], s59 offen nt
  s_waitcnt vmcnt(7)
  s_add_u32 s59, s57, 77824
  buffer_load_dwordx4 a[140:143], v2, s[28:31], s59 offen nt
  s_waitcnt vmcnt(7)
  s_add_u32 s59, s57, 81920
  buffer_load_dwordx4 a[144:147], v2, s[28:31], s59 offen nt
  s_waitcnt vmcnt(7)
  s_add_u32 s59, s57, 86016
  buffer_load_dwordx4 a[148:151], v2, s[28:31], s59 offen nt
  s_waitcnt vmcnt(7)
  s_add_u32 s59, s57, 90112
  buffer_load_dwordx4 a[152:155], v2, s[28:31], s59 offen nt
  s_waitcnt vmcnt(7)
  s_add_u32 s59, s57, 94208
  buffer_load_dwordx4 a[156:159], v2, s[28:31], s59 offen nt
  s_mov_b32 s68, 4
  s_mov_b32 s69, 3
  ds_read_b32 v204, v4 offset:1028
  ds_read_b128 v[8:11], v211 offset:2048
  s_waitcnt lgkmcnt(0)
  v_cmp_ne_u32 vcc, 0, v204
  s_cbranch_vccnz L_qdone
  s_waitcnt vmcnt(7)
  v_mov_b32 v23, 1
  s_mov_b64 exec, 1
  buffer_atomic_add v23, v201, s[48:51], 0 offen sc0 sc1
  s_mov_b64 exec, -1
  s_waitcnt vmcnt(7)
  s_add_u32 s59, s57, 65536
  buffer_load_dwordx4 a[160:163], v3, s[32:35], s59 offen nt
  s_waitcnt vmcnt(7)
  s_add_u32 s59, s57, 69632
  buffer_load_dwordx4 a[164:167], v3, s[32:35], s59 offen nt
  s_waitcnt vmcnt(7)
  s_add_u32 s59, s57, 73728
  buffer_load_dwordx4 a[168:171], v3, s[32:35], s59 offen nt
  s_waitcnt vmcnt(7)
  s_add_u32 s59, s57, 77824
  buffer_load_dwordx4 a[172:175], v3, s[32:35], s59 offen nt
  s_waitcnt vmcnt(7)
  s_add_u32 s59, s57, 81920
  buffer_load_dwordx4 a[176:179], v3, s[32:35], s59 offen nt
  s_waitcnt vmcnt(7)
  s_add_u32 s59, s57, 86016
  buffer_load_dwordx4 a[180:183], v3, s[32:35], s59 offen nt
  s_waitcnt vmcnt(7)
  s_add_u32 s59, s57, 90112
  buffer_load_dwordx4 a[184:187], v3, s[32:35], s59 offen nt
  s_waitcnt vmcnt(7)
  s_add_u32 s59, s57, 94208
  buffer_load_dwordx4 a[188:191], v3, s[32:35], s59 offen nt
  s_mov_b32 s68, 5
  s_mov_b32 s69, 4
  ds_read_b32 v204, v4 offset:1028
  ds_read_b128 v[8:11], v211 offset:2048
  s_waitcnt lgkmcnt(0)
  v_cmp_ne_u32 vcc, 0, v204
  s_cbranch_vccnz L_qdone
  s_waitcnt vmcnt(7)
  s_add_u32 s59, s57, 98304
  buffer_load_dwordx4 a[192:195], v2, s[28:31], s59 offen nt
  s_waitcnt vmcnt(7)
  s_add_u32 s59, s57, 102400
  buffer_load_dwordx4 a[196:199], v2, s[28:31], s59 offen nt
  s_waitcnt vmcnt(7)
  s_add_u32 s59, s57, 106496
  buffer_load_dwordx4 a[200:203], v2, s[28:31], s59 offen nt
  s_waitcnt vmcnt(7)
  s_add_u32 s59, s57, 110592
  buffer_load_dwordx4 a[204:207], v2, s[28:31], s59 offen nt
  s_waitcnt vmcnt(7)
  s_add_u32 s59, s57, 114688
  buffer_load_dwordx4 a[208:211], v2, s[28:31], s59 offen nt
  s_waitcnt vmcnt(7)
  s_add_u32 s59, s57, 118784
  buffer_load_dwordx4 a[212:215], v2, s[28:31], s59 offen nt
  s_waitcnt vmcnt(7)
  s_add_u32 s59, s57, 122880
  buffer_load_dwordx4 a[216:219], v2, s[28:31], s59 offen nt
  s_waitcnt vmcnt(7)
  s_add_u32 s59, s57, 126976
  buffer_load_dwordx4 a[220:223], v2, s[28:31], s59 offen nt
  s_mov_b32 s68, 6
  s_mov_b32 s69, 5
  ds_read_b32 v204, v4 offset:1028
  ds_read_b128 v[8:11], v211 offset:2048
  s_waitcnt lgkmcnt(0)
  v_cmp_ne_u32 vcc, 0, v204
  s_cbranch_vccnz L_qdone
  s_waitcnt vmcnt(7)
  v_mov_b32 v23, 1
  s_mov_b64 exec, 1
  buffer_atomic_add v23, v201, s[48:51], 0 offen sc0 sc1
  s_mov_b64 exec, -1
  s_waitcnt vmcnt(7)
  s_add_u32 s59, s57, 98304
  buffer_load_dwordx4 a[224:227], v3, s[32:35], s59 offen nt
  s_waitcnt vmcnt(7)
  s_add_u32 s59, s57, 102400
  buffer_load_dwordx4 a[228:231], v3, s[32:35], s59 offen nt
  s_waitcnt vmcnt(7)
  s_add_u32 s59, s57, 106496
  buffer_load_dwordx4 a[232:235], v3, s[32:35], s59 offen nt
  s_waitcnt vmcnt(7)
  s_add_u32 s59, s57, 110592
  buffer_load_dwordx4 a[236:239], v3, s[32:35], s59 offen nt
  s_waitcnt vmcnt(7)
  s_add_u32 s59, s57, 114688
  buffer_load_dwordx4 a[240:243], v3, s[32:35], s59 offen nt
  s_waitcnt vmcnt(7)
  s_add_u32 s59, s57, 118784
  buffer_load_dwordx4 a[244:247], v3, s[32:35], s59 offen nt
  s_waitcnt vmcnt(7)
  s_add_u32 s59, s57, 122880
  buffer_load_dwordx4 a[248:251], v3, s[32:35], s59 offen nt
  s_waitcnt vmcnt(7)
  s_add_u32 s59, s57, 126976
  buffer_load_dwordx4 a[252:255], v3, s[32:35], s59 offen nt
  s_mov_b32 s68, 7
  s_mov_b32 s69, 6
  s_mov_b32 s64, 1600000
L_qspin:
  ds_read_b32 v204, v4 offset:1028
  ds_read_b128 v[8:11], v211 offset:2048
  s_waitcnt lgkmcnt(0)
  v_cmp_ne_u32 vcc, 0, v204
  s_cbranch_vccnz L_qdone
  s_sleep 2
  s_sub_u32 s64, s64, 1
  s_cmp_lg_u32 s64, 0
  s_cbranch_scc1 L_qspin
L_qdone:
  s_cmp_eq_u32 s55, 1
  s_cselect_b32 s79, 23, 23
L_loop:
  s_sub_u32 s68, s68, 1
  s_cbranch_scc0 L_gwK0
  s_mov_b32 s68, 0
  s_waitcnt vmcnt(9)
L_gwK0:
  v_mfma_f32_16x16x32_bf16 v[40:43], a[0:3], v[8:11], 0
  v_mfma_f32_16x16x32_bf16 v[44:47], a[4:7], v[8:11], 0
  v_mfma_f32_16x16x32_bf16 v[48:51], a[8:11], v[8:11], 0
  v_mfma_f32_16x16x32_bf16 v[52:55], a[12:15], v[8:11], 0
  v_mfma_f32_16x16x32_bf16 v[56:59], a[16:19], v[8:11], 0
  v_mfma_f32_16x16x32_bf16 v[60:63], a[20:23], v[8:11], 0
  v_mfma_f32_16x16x32_bf16 v[64:67], a[24:27], v[8:11], 0
  v_mfma_f32_16x16x32_bf16 v[68:71], a[28:31], v[8:11], 0
  s_add_u32 s58, s58, 1
  s_add_u32 s57, s57, 0x8000
  s_cmp_ge_u32 s58, 13
  s_cselect_b32 s50, 8388608, 0
  v_mov_b32_dpp v76, v40 quad_perm:[0,1,2,3] row_mask:0xf bank_mask:0x1
  v_mov_b32_dpp v77, v42 row_ror:8 row_mask:0xf bank_mask:0x1
  v_mov_b32_dpp v78, v56 quad_perm:[0,1,2,3] row_mask:0xf bank_mask:0x1
  v_mov_b32_dpp v79, v58 row_ror:8 row_mask:0xf bank_mask:0x1
  v_mov_b32_dpp v76, v44 row_ror:4 row_mask:0xf bank_mask:0x2
  v_mov_b32_dpp v77, v46 row_ror:12 row_mask:0xf bank_mask:0x2
  v_mov_b32_dpp v78, v60 row_ror:4 row_mask:0xf bank_mask:0x2
  v_mov_b32_dpp v79, v62 row_ror:12 row_mask:0xf bank_mask:0x2
  v_mov_b32_dpp v76, v48 row_ror:8 row_mask:0xf bank_mask:0x4
  v_mov_b32_dpp v77, v50 quad_perm:[0,1,2,3] row_mask:0xf bank_mask:0x4
  v_mov_b32_dpp v78, v64 row_ror:8 row_mask:0xf bank_mask:0x4
  v_mov_b32_dpp v79, v66 quad_perm:[0,1,2,3] row_mask:0xf bank_mask:0x4
  v_mov_b32_dpp v76, v52 row_ror:12 row_mask:0xf bank_mask:0x8
  v_mov_b32_dpp v77, v54 row_ror:4 row_mask:0xf bank_mask:0x8
  v_mov_b32_dpp v78, v68 row_ror:12 row_mask:0xf bank_mask:0x8
  v_mov_b32_dpp v79, v70 row_ror:4 row_mask:0xf bank_mask:0x8
  v_add_f32_dpp v76, v41, v76 row_ror:12 row_mask:0xf bank_mask:0x1
  v_add_f32_dpp v77, v43, v77 row_ror:4 row_mask:0xf bank_mask:0x1
  v_add_f32_dpp v78, v57, v78 row_ror:12 row_mask:0xf bank_mask:0x1
  v_add_f32_dpp v79, v59, v79 row_ror:4 row_mask:0xf bank_mask:0x1
  v_add_f32_dpp v76, v45, v76 quad_perm:[0,1,2,3] row_mask:0xf bank_mask:0x2
  v_add_f32_dpp v77, v47, v77 row_ror:8 row_mask:0xf bank_mask:0x2
  v_add_f32_dpp v78, v61, v78 quad_perm:[0,1,2,3] row_mask:0xf bank_mask:0x2
  v_add_f32_dpp v79, v63, v79 row_ror:8 row_mask:0xf bank_mask:0x2
  v_add_f32_dpp v76, v49, v76 row_ror:4 row_mask:0xf bank_mask:0x4
  v_add_f32_dpp v77, v51, v77 row_ror:12 row_mask:0xf bank_mask:0x4
  v_add_f32_dpp v78, v65, v78 row_ror:4 row_mask:0xf bank_mask:0x4
  v_add_f32_dpp v79, v67, v79 row_ror:12 row_mask:0xf bank_mask:0x4
  v_add_f32_dpp v76, v53, v76 row_ror:8 row_mask:0xf bank_mask:0x8
  v_add_f32_dpp v77, v55, v77 quad_perm:[0,1,2,3] row_mask:0xf bank_mask:0x8
  v_add_f32_dpp v78, v69, v78 row_ror:8 row_mask:0xf bank_mask:0x8
  v_add_f32_dpp v79, v71, v79 quad_perm:[0,1,2,3] row_mask:0xf bank_mask:0x8
  v_add_f32 v72, v76, v77
  v_add_f32 v73, v78, v79
  v_cvt_pk_bf16_f32 v74, v72, v73
  v_lshlrev_b32 v72, 16, v74
  v_and_b32 v73, 0xffff0000, v74
  v_mul_f32 v72, 0x3db504f3, v72
  v_mul_f32 v73, 0x3db504f3, v73
  v_cvt_pk_bf16_f32 v74, v72, v73
  v_lshlrev_b32 v72, 16, v74
  v_and_b32 v73, 0xffff0000, v74
  v_max_f32 v84, v72, v73
  v_cmp_gt_f32 vcc, v84, v22
  s_cbranch_vccz L_nors0
  v_max_f32_dpp v84, v84, v84 row_ror:4 row_mask:0xf bank_mask:0xf
  s_nop 1
  v_max_f32_dpp v84, v84, v84 row_ror:8 row_mask:0xf bank_mask:0xf
  v_mov_b32 v85, v84
  s_nop 1
  v_permlane16_swap_b32 v84, v85
  v_max_f32 v84, v84, v85
  v_mov_b32 v85, v84
  s_nop 1
  v_permlane32_swap_b32 v84, v85
  v_max_f32 v84, v84, v85
  v_max_f32 v84, v84, v22
  v_sub_f32 v85, v22, v84
  v_mul_f32 v85, 0x3fb8aa3b, v85
  v_exp_f32 v85, v85
  v_mov_b32 v22, v84
  v_mul_f32 v20, 0xbfb8aa3b, v84
  v_mul_f32 v21, v21, v85
  v_mul_f32 v12, v12, v85
  v_mul_f32 v13, v13, v85
  v_mul_f32 v14, v14, v85
  v_mul_f32 v15, v15, v85
  v_mul_f32 v16, v16, v85
  v_mul_f32 v17, v17, v85
  v_mul_f32 v18, v18, v85
  v_mul_f32 v19, v19, v85
L_nors0:
  v_fma_f32 v72, v72, s73, v20
  v_fma_f32 v73, v73, s73, v20
  v_exp_f32 v72, v72
  v_exp_f32 v73, v73
  v_add_f32 v21, v21, v72
  v_cvt_pk_bf16_f32 v74, v72, v73
  v_add_f32 v21, v21, v73
  v_and_b32 v80, 0xffff, v74
  v_lshlrev_b32 v81, 16, v74
  v_lshrrev_b32 v82, 16, v74
  v_and_b32 v83, 0xffff0000, v74
  v_mov_b32_dpp v24, v80 quad_perm:[0,1,2,3] row_mask:0xf bank_mask:0x1
  v_mov_b32_dpp v25, v80 row_ror:8 row_mask:0xf bank_mask:0x4
  v_mov_b32_dpp v26, v80 row_ror:12 row_mask:0xf bank_mask:0x1
  v_mov_b32_dpp v27, v80 row_ror:4 row_mask:0xf bank_mask:0x4
  v_mov_b32_dpp v24, v81 row_ror:4 row_mask:0xf bank_mask:0x2
  v_mov_b32_dpp v25, v81 row_ror:12 row_mask:0xf bank_mask:0x8
  v_mov_b32_dpp v26, v81 quad_perm:[0,1,2,3] row_mask:0xf bank_mask:0x2
  v_mov_b32_dpp v27, v81 row_ror:8 row_mask:0xf bank_mask:0x8
  v_mov_b32_dpp v28, v80 row_ror:8 row_mask:0xf bank_mask:0x1
  v_mov_b32_dpp v29, v80 quad_perm:[0,1,2,3] row_mask:0xf bank_mask:0x4
  v_mov_b32_dpp v30, v80 row_ror:4 row_mask:0xf bank_mask:0x1
  v_mov_b32_dpp v31, v80 row_ror:12 row_mask:0xf bank_mask:0x4
  v_mov_b32_dpp v28, v81 row_ror:12 row_mask:0xf bank_mask:0x2
  v_mov_b32_dpp v29, v81 row_ror:4 row_mask:0xf bank_mask:0x8
  v_mov_b32_dpp v30, v81 row_ror:8 row_mask:0xf bank_mask:0x2
  v_mov_b32_dpp v31, v81 quad_perm:[0,1,2,3] row_mask:0xf bank_mask:0x8
  v_mov_b32_dpp v32, v82 quad_perm:[0,1,2,3] row_mask:0xf bank_mask:0x1
  v_mov_b32_dpp v33, v82 row_ror:8 row_mask:0xf bank_mask:0x4
  v_mov_b32_dpp v34, v82 row_ror:12 row_mask:0xf bank_mask:0x1
  v_mov_b32_dpp v35, v82 row_ror:4 row_mask:0xf bank_mask:0x4
  v_mov_b32_dpp v32, v83 row_ror:4 row_mask:0xf bank_mask:0x2
  v_mov_b32_dpp v33, v83 row_ror:12 row_mask:0xf bank_mask:0x8
  v_mov_b32_dpp v34, v83 quad_perm:[0,1,2,3] row_mask:0xf bank_mask:0x2
  v_mov_b32_dpp v35, v83 row_ror:8 row_mask:0xf bank_mask:0x8
  v_mov_b32_dpp v36, v82 row_ror:8 row_mask:0xf bank_mask:0x1
  v_mov_b32_dpp v37, v82 quad_perm:[0,1,2,3] row_mask:0xf bank_mask:0x4
  v_mov_b32_dpp v38, v82 row_ror:4 row_mask:0xf bank_mask:0x1
  v_mov_b32_dpp v39, v82 row_ror:12 row_mask:0xf bank_mask:0x4
  v_mov_b32_dpp v36, v83 row_ror:12 row_mask:0xf bank_mask:0x2
  v_mov_b32_dpp v37, v83 row_ror:4 row_mask:0xf bank_mask:0x8
  v_mov_b32_dpp v38, v83 row_ror:8 row_mask:0xf bank_mask:0x2
  v_mov_b32_dpp v39, v83 quad_perm:[0,1,2,3] row_mask:0xf bank_mask:0x8
  s_sub_u32 s69, s69, 1
  s_cbranch_scc0 L_sk0K
  s_mov_b32 s69, 0
  s_cmp_lt_u32 s58, 6
  s_cbranch_scc1 L_st0
  s_waitcnt vmcnt(4)
  s_cmp_lt_u32 s58, 14
  s_cbranch_scc1 L_st0
  v_readfirstlane_b32 s59, v23
  s_and_b32 s57, s59, 7
  s_add_u32 s65, s59, s77
  s_and_b32 s65, s65, 3
  s_lshl3_add_u32 s57, s65, s57
  s_lshl_b32 s57, s57, 19
  s_lshr_b32 s65, s59, 3
  s_min_u32 s72, s65, 1
  s_add_u32 s65, s65, s72
  s_add_u32 s65, s65, 28
  s_lshl_b32 s65, s65, 14
  s_add_u32 s57, s57, s65
  s_cmp_lt_u32 s59, 8
  s_cbranch_scc1 L_st0
  s_mov_b32 s67, 3
  s_cmp_ge_u32 s59, 24
  s_cbranch_scc1 L_fl0
  s_cmp_ge_u32 s59, s79
  s_cselect_b32 s67, 1, 2
  s_cselect_b32 s50, 0, 8388608
  buffer_load_dwordx4 v[88:91], v2, s[28:31], s57 offen nt
  s_add_u32 s59, s57, 4096
  buffer_load_dwordx4 v[92:95], v2, s[28:31], s59 offen nt
  s_add_u32 s59, s57, 8192
  buffer_load_dwordx4 v[96:99], v2, s[28:31], s59 offen nt
  s_add_u32 s59, s57, 12288
  buffer_load_dwordx4 v[100:103], v2, s[28:31], s59 offen nt
  buffer_load_dwordx4 v[104:107], v3, s[32:35], s57 offen nt
  s_add_u32 s59, s57, 4096
  buffer_load_dwordx4 v[108:111], v3, s[32:35], s59 offen nt
  s_add_u32 s59, s57, 8192
  buffer_load_dwordx4 v[112:115], v3, s[32:35], s59 offen nt
  s_add_u32 s59, s57, 12288
  buffer_load_dwordx4 v[116:119], v3, s[32:35], s59 offen nt
  v_mov_b32 v23, 1
  s_mov_b64 exec, 1
  buffer_atomic_add v23, v201, s[48:51], 0 offen sc0 sc1
  s_mov_b64 exec, -1
  s_waitcnt vmcnt(9)
  s_branch L_gwV0
L_fl0:
  s_waitcnt vmcnt(0)
  s_branch L_gwV0
L_st0:
  buffer_load_dwordx4 a[64:67], v2, s[28:31], s57 offen nt
  s_add_u32 s59, s57, 4096
  buffer_load_dwordx4 a[68:71], v2, s[28:31], s59 offen nt
  s_add_u32 s59, s57, 8192
  buffer_load_dwordx4 a[72:75], v2, s[28:31], s59 offen nt
  s_add_u32 s59, s57, 12288
  buffer_load_dwordx4 a[76:79], v2, s[28:31], s59 offen nt
  s_add_u32 s59, s57, 16384
  buffer_load_dwordx4 a[80:83], v2, s[28:31], s59 offen nt
  s_add_u32 s59, s57, 20480
  buffer_load_dwordx4 a[84:87], v2, s[28:31], s59 offen nt
  s_add_u32 s59, s57, 24576
  buffer_load_dwordx4 a[88:91], v2, s[28:31], s59 offen nt
  s_add_u32 s59, s57, 28672
  buffer_load_dwordx4 a[92:95], v2, s[28:31], s59 offen nt
L_sk0K:
  s_sub_u32 s68, s68, 1
  s_cbranch_scc0 L_gwV0
  s_mov_b32 s68, 0
  s_waitcnt vmcnt(8)
L_gwV0:
  v_mfma_f32_16x16x16_bf16 v[12:15], a[32:33], v[24:25], v[12:15]
  v_mfma_f32_16x16x16_bf16 v[16:19], a[34:35], v[24:25], v[16:19]
  v_mfma_f32_16x16x16_bf16 v[12:15], a[36:37], v[26:27], v[12:15]
  v_mfma_f32_16x16x16_bf16 v[16:19], a[38:39], v[26:27], v[16:19]
  v_mfma_f32_16x16x16_bf16 v[12:15], a[40:41], v[28:29], v[12:15]
  v_mfma_f32_16x16x16_bf16 v[16:19], a[42:43], v[28:29], v[16:19]
  v_mfma_f32_16x16x16_bf16 v[12:15], a[44:45], v[30:31], v[12:15]
  v_mfma_f32_16x16x16_bf16 v[16:19], a[46:47], v[30:31], v[16:19]
  v_mfma_f32_16x16x16_bf16 v[12:15], a[48:49], v[32:33], v[12:15]
  v_mfma_f32_16x16x16_bf16 v[16:19], a[50:51], v[32:33], v[16:19]
  v_mfma_f32_16x16x16_bf16 v[12:15], a[52:53], v[34:35], v[12:15]
  v_mfma_f32_16x16x16_bf16 v[16:19], a[54:55], v[34:35], v[16:19]
  v_mfma_f32_16x16x16_bf16 v[12:15], a[56:57], v[36:37], v[12:15]
  v_mfma_f32_16x16x16_bf16 v[16:19], a[58:59], v[36:37], v[16:19]
  v_mfma_f32_16x16x16_bf16 v[12:15], a[60:61], v[38:39], v[12:15]
  v_mfma_f32_16x16x16_bf16 v[16:19], a[62:63], v[38:39], v[16:19]
  s_cmp_lg_u32 s67, 0
  s_cbranch_scc1 L_half
  s_sub_u32 s69, s69, 1
  s_cbranch_scc0 L_sk0V
  s_mov_b32 s69, 0
  s_cmp_lt_u32 s58, 6
  s_cbranch_scc1 L_sk0Vd
  s_waitcnt vmcnt(4)
L_sk0Vd:
  v_mov_b32 v23, 1
  s_mov_b64 exec, 1
  buffer_atomic_add v23, v201, s[48:51], 0 offen sc0 sc1
  s_mov_b64 exec, -1
  buffer_load_dwordx4 a[96:99], v3, s[32:35], s57 offen nt
  s_add_u32 s59, s57, 4096
  buffer_load_dwordx4 a[100:103], v3, s[32:35], s59 offen nt
  s_add_u32 s59, s57, 8192
  buffer_load_dwordx4 a[104:107], v3, s[32:35], s59 offen nt
  s_add_u32 s59, s57, 12288
  buffer_load_dwordx4 a[108:111], v3, s[32:35], s59 offen nt
  s_add_u32 s59, s57, 16384
  buffer_load_dwordx4 a[112:115], v3, s[32:35], s59 offen nt
  s_add_u32 s59, s57, 20480
  buffer_load_dwordx4 a[116:119], v3, s[32:35], s59 offen nt
  s_add_u32 s59, s57, 24576
  buffer_load_dwordx4 a[120:123], v3, s[32:35], s59 offen nt
  s_add_u32 s59, s57, 28672
  buffer_load_dwordx4 a[124:127], v3, s[32:35], s59 offen nt
L_sk0V:
  s_sub_u32 s68, s68, 1
  s_cbranch_scc0 L_gwK1
  s_mov_b32 s68, 0
  s_waitcnt vmcnt(9)
L_gwK1:
  v_mfma_f32_16x16x32_bf16 v[40:43], a[64:67], v[8:11], 0
  v_mfma_f32_16x16x32_bf16 v[44:47], a[68:71], v[8:11], 0
  v_mfma_f32_16x16x32_bf16 v[48:51], a[72:75], v[8:11], 0
  v_mfma_f32_16x16x32_bf16 v[52:55], a[76:79], v[8:11], 0
  v_mfma_f32_16x16x32_bf16 v[56:59], a[80:83], v[8:11], 0
  v_mfma_f32_16x16x32_bf16 v[60:63], a[84:87], v[8:11], 0
  v_mfma_f32_16x16x32_bf16 v[64:67], a[88:91], v[8:11], 0
  v_mfma_f32_16x16x32_bf16 v[68:71], a[92:95], v[8:11], 0
  s_add_u32 s58, s58, 1
  s_add_u32 s57, s57, 0x8000
  s_cmp_ge_u32 s58, 13
  s_cselect_b32 s50, 8388608, 0
  v_mov_b32_dpp v76, v40 quad_perm:[0,1,2,3] row_mask:0xf bank_mask:0x1
  v_mov_b32_dpp v77, v42 row_ror:8 row_mask:0xf bank_mask:0x1
  v_mov_b32_dpp v78, v56 quad_perm:[0,1,2,3] row_mask:0xf bank_mask:0x1
  v_mov_b32_dpp v79, v58 row_ror:8 row_mask:0xf bank_mask:0x1
  v_mov_b32_dpp v76, v44 row_ror:4 row_mask:0xf bank_mask:0x2
  v_mov_b32_dpp v77, v46 row_ror:12 row_mask:0xf bank_mask:0x2
  v_mov_b32_dpp v78, v60 row_ror:4 row_mask:0xf bank_mask:0x2
  v_mov_b32_dpp v79, v62 row_ror:12 row_mask:0xf bank_mask:0x2
  v_mov_b32_dpp v76, v48 row_ror:8 row_mask:0xf bank_mask:0x4
  v_mov_b32_dpp v77, v50 quad_perm:[0,1,2,3] row_mask:0xf bank_mask:0x4
  v_mov_b32_dpp v78, v64 row_ror:8 row_mask:0xf bank_mask:0x4
  v_mov_b32_dpp v79, v66 quad_perm:[0,1,2,3] row_mask:0xf bank_mask:0x4
  v_mov_b32_dpp v76, v52 row_ror:12 row_mask:0xf bank_mask:0x8
  v_mov_b32_dpp v77, v54 row_ror:4 row_mask:0xf bank_mask:0x8
  v_mov_b32_dpp v78, v68 row_ror:12 row_mask:0xf bank_mask:0x8
  v_mov_b32_dpp v79, v70 row_ror:4 row_mask:0xf bank_mask:0x8
  v_add_f32_dpp v76, v41, v76 row_ror:12 row_mask:0xf bank_mask:0x1
  v_add_f32_dpp v77, v43, v77 row_ror:4 row_mask:0xf bank_mask:0x1
  v_add_f32_dpp v78, v57, v78 row_ror:12 row_mask:0xf bank_mask:0x1
  v_add_f32_dpp v79, v59, v79 row_ror:4 row_mask:0xf bank_mask:0x1
  v_add_f32_dpp v76, v45, v76 quad_perm:[0,1,2,3] row_mask:0xf bank_mask:0x2
  v_add_f32_dpp v77, v47, v77 row_ror:8 row_mask:0xf bank_mask:0x2
  v_add_f32_dpp v78, v61, v78 quad_perm:[0,1,2,3] row_mask:0xf bank_mask:0x2
  v_add_f32_dpp v79, v63, v79 row_ror:8 row_mask:0xf bank_mask:0x2
  v_add_f32_dpp v76, v49, v76 row_ror:4 row_mask:0xf bank_mask:0x4
  v_add_f32_dpp v77, v51, v77 row_ror:12 row_mask:0xf bank_mask:0x4
  v_add_f32_dpp v78, v65, v78 row_ror:4 row_mask:0xf bank_mask:0x4
  v_add_f32_dpp v79, v67, v79 row_ror:12 row_mask:0xf bank_mask:0x4
  v_add_f32_dpp v76, v53, v76 row_ror:8 row_mask:0xf bank_mask:0x8
  v_add_f32_dpp v77, v55, v77 quad_perm:[0,1,2,3] row_mask:0xf bank_mask:0x8
  v_add_f32_dpp v78, v69, v78 row_ror:8 row_mask:0xf bank_mask:0x8
  v_add_f32_dpp v79, v71, v79 quad_perm:[0,1,2,3] row_mask:0xf bank_mask:0x8
  v_add_f32 v72, v76, v77
  v_add_f32 v73, v78, v79
  v_cvt_pk_bf16_f32 v74, v72, v73
  v_lshlrev_b32 v72, 16, v74
  v_and_b32 v73, 0xffff0000, v74
  v_mul_f32 v72, 0x3db504f3, v72
  v_mul_f32 v73, 0x3db504f3, v73
  v_cvt_pk_bf16_f32 v74, v72, v73
  v_lshlrev_b32 v72, 16, v74
  v_and_b32 v73, 0xffff0000, v74
  v_max_f32 v84, v72, v73
  v_cmp_gt_f32 vcc, v84, v22
  s_cbranch_vccz L_nors1
  v_max_f32_dpp v84, v84, v84 row_ror:4 row_mask:0xf bank_mask:0xf
  s_nop 1
  v_max_f32_dpp v84, v84, v84 row_ror:8 row_mask:0xf bank_mask:0xf
  v_mov_b32 v85, v84
  s_nop 1
  v_permlane16_swap_b32 v84, v85
  v_max_f32 v84, v84, v85
  v_mov_b32 v85, v84
  s_nop 1
  v_permlane32_swap_b32 v84, v85
  v_max_f32 v84, v84, v85
  v_max_f32 v84, v84, v22
  v_sub_f32 v85, v22, v84
  v_mul_f32 v85, 0x3fb8aa3b, v85
  v_exp_f32 v85, v85
  v_mov_b32 v22, v84
  v_mul_f32 v20, 0xbfb8aa3b, v84
  v_mul_f32 v21, v21, v85
  v_mul_f32 v12, v12, v85
  v_mul_f32 v13, v13, v85
  v_mul_f32 v14, v14, v85
  v_mul_f32 v15, v15, v85
  v_mul_f32 v16, v16, v85
  v_mul_f32 v17, v17, v85
  v_mul_f32 v18, v18, v85
  v_mul_f32 v19, v19, v85
L_nors1:
  v_fma_f32 v72, v72, s73, v20
  v_fma_f32 v73, v73, s73, v20
  v_exp_f32 v72, v72
  v_exp_f32 v73, v73
  v_add_f32 v21, v21, v72
  v_cvt_pk_bf16_f32 v74, v72, v73
  v_add_f32 v21, v21, v73
  v_and_b32 v80, 0xffff, v74
  v_lshlrev_b32 v81, 16, v74
  v_lshrrev_b32 v82, 16, v74
  v_and_b32 v83, 0xffff0000, v74
  v_mov_b32_dpp v24, v80 quad_perm:[0,1,2,3] row_mask:0xf bank_mask:0x1
  v_mov_b32_dpp v25, v80 row_ror:8 row_mask:0xf bank_mask:0x4
  v_mov_b32_dpp v26, v80 row_ror:12 row_mask:0xf bank_mask:0x1
  v_mov_b32_dpp v27, v80 row_ror:4 row_mask:0xf bank_mask:0x4
  v_mov_b32_dpp v24, v81 row_ror:4 row_mask:0xf bank_mask:0x2
  v_mov_b32_dpp v25, v81 row_ror:12 row_mask:0xf bank_mask:0x8
  v_mov_b32_dpp v26, v81 quad_perm:[0,1,2,3] row_mask:0xf bank_mask:0x2
  v_mov_b32_dpp v27, v81 row_ror:8 row_mask:0xf bank_mask:0x8
  v_mov_b32_dpp v28, v80 row_ror:8 row_mask:0xf bank_mask:0x1
  v_mov_b32_dpp v29, v80 quad_perm:[0,1,2,3] row_mask:0xf bank_mask:0x4
  v_mov_b32_dpp v30, v80 row_ror:4 row_mask:0xf bank_mask:0x1
  v_mov_b32_dpp v31, v80 row_ror:12 row_mask:0xf bank_mask:0x4
  v_mov_b32_dpp v28, v81 row_ror:12 row_mask:0xf bank_mask:0x2
  v_mov_b32_dpp v29, v81 row_ror:4 row_mask:0xf bank_mask:0x8
  v_mov_b32_dpp v30, v81 row_ror:8 row_mask:0xf bank_mask:0x2
  v_mov_b32_dpp v31, v81 quad_perm:[0,1,2,3] row_mask:0xf bank_mask:0x8
  v_mov_b32_dpp v32, v82 quad_perm:[0,1,2,3] row_mask:0xf bank_mask:0x1
  v_mov_b32_dpp v33, v82 row_ror:8 row_mask:0xf bank_mask:0x4
  v_mov_b32_dpp v34, v82 row_ror:12 row_mask:0xf bank_mask:0x1
  v_mov_b32_dpp v35, v82 row_ror:4 row_mask:0xf bank_mask:0x4
  v_mov_b32_dpp v32, v83 row_ror:4 row_mask:0xf bank_mask:0x2
  v_mov_b32_dpp v33, v83 row_ror:12 row_mask:0xf bank_mask:0x8
  v_mov_b32_dpp v34, v83 quad_perm:[0,1,2,3] row_mask:0xf bank_mask:0x2
  v_mov_b32_dpp v35, v83 row_ror:8 row_mask:0xf bank_mask:0x8
  v_mov_b32_dpp v36, v82 row_ror:8 row_mask:0xf bank_mask:0x1
  v_mov_b32_dpp v37, v82 quad_perm:[0,1,2,3] row_mask:0xf bank_mask:0x4
  v_mov_b32_dpp v38, v82 row_ror:4 row_mask:0xf bank_mask:0x1
  v_mov_b32_dpp v39, v82 row_ror:12 row_mask:0xf bank_mask:0x4
  v_mov_b32_dpp v36, v83 row_ror:12 row_mask:0xf bank_mask:0x2
  v_mov_b32_dpp v37, v83 row_ror:4 row_mask:0xf bank_mask:0x8
  v_mov_b32_dpp v38, v83 row_ror:8 row_mask:0xf bank_mask:0x2
  v_mov_b32_dpp v39, v83 quad_perm:[0,1,2,3] row_mask:0xf bank_mask:0x8
  s_sub_u32 s69, s69, 1
  s_cbranch_scc0 L_sk1K
  s_mov_b32 s69, 0
  s_cmp_lt_u32 s58, 6
  s_cbranch_scc1 L_st1
  s_waitcnt vmcnt(4)
  s_cmp_lt_u32 s58, 14
  s_cbranch_scc1 L_st1
  v_readfirstlane_b32 s59, v23
  s_and_b32 s57, s59, 7
  s_add_u32 s65, s59, s77
  s_and_b32 s65, s65, 3
  s_lshl3_add_u32 s57, s65, s57
  s_lshl_b32 s57, s57, 19
  s_lshr_b32 s65, s59, 3
  s_min_u32 s72, s65, 1
  s_add_u32 s65, s65, s72
  s_add_u32 s65, s65, 28
  s_lshl_b32 s65, s65, 14
  s_add_u32 s57, s57, s65
  s_cmp_lt_u32 s59, 8
  s_cbranch_scc1 L_st1
  s_mov_b32 s67, 3
  s_cmp_ge_u32 s59, 24
  s_cbranch_scc1 L_fl1
  s_cmp_ge_u32 s59, s79
  s_cselect_b32 s67, 1, 2
  s_cselect_b32 s50, 0, 8388608
  buffer_load_dwordx4 v[88:91], v2, s[28:31], s57 offen nt
  s_add_u32 s59, s57, 4096
  buffer_load_dwordx4 v[92:95], v2, s[28:31], s59 offen nt
  s_add_u32 s59, s57, 8192
  buffer_load_dwordx4 v[96:99], v2, s[28:31], s59 offen nt
  s_add_u32 s59, s57, 12288
  buffer_load_dwordx4 v[100:103], v2, s[28:31], s59 offen nt
  buffer_load_dwordx4 v[104:107], v3, s[32:35], s57 offen nt
  s_add_u32 s59, s57, 4096
  buffer_load_dwordx4 v[108:111], v3, s[32:35], s59 offen nt
  s_add_u32 s59, s57, 8192
  buffer_load_dwordx4 v[112:115], v3, s[32:35], s59 offen nt
  s_add_u32 s59, s57, 12288
  buffer_load_dwordx4 v[116:119], v3, s[32:35], s59 offen nt
  v_mov_b32 v23, 1
  s_mov_b64 exec, 1
  buffer_atomic_add v23, v201, s[48:51], 0 offen sc0 sc1
  s_mov_b64 exec, -1
  s_waitcnt vmcnt(9)
  s_branch L_gwV1
L_fl1:
  s_waitcnt vmcnt(0)
  s_branch L_gwV1
L_st1:
  buffer_load_dwordx4 a[128:131], v2, s[28:31], s57 offen nt
  s_add_u32 s59, s57, 4096
  buffer_load_dwordx4 a[132:135], v2, s[28:31], s59 offen nt
  s_add_u32 s59, s57, 8192
  buffer_load_dwordx4 a[136:139], v2, s[28:31], s59 offen nt
  s_add_u32 s59, s57, 12288
  buffer_load_dwordx4 a[140:143], v2, s[28:31], s59 offen nt
  s_add_u32 s59, s57, 16384
  buffer_load_dwordx4 a[144:147], v2, s[28:31], s59 offen nt
  s_add_u32 s59, s57, 20480
  buffer_load_dwordx4 a[148:151], v2, s[28:31], s59 offen nt
  s_add_u32 s59, s57, 24576
  buffer_load_dwordx4 a[152:155], v2, s[28:31], s59 offen nt
  s_add_u32 s59, s57, 28672
  buffer_load_dwordx4 a[156:159], v2, s[28:31], s59 offen nt
L_sk1K:
  s_sub_u32 s68, s68, 1
  s_cbranch_scc0 L_gwV1
  s_mov_b32 s68, 0
  s_waitcnt vmcnt(8)
L_gwV1:
  v_mfma_f32_16x16x16_bf16 v[12:15], a[96:97], v[24:25], v[12:15]
  v_mfma_f32_16x16x16_bf16 v[16:19], a[98:99], v[24:25], v[16:19]
  v_mfma_f32_16x16x16_bf16 v[12:15], a[100:101], v[26:27], v[12:15]
  v_mfma_f32_16x16x16_bf16 v[16:19], a[102:103], v[26:27], v[16:19]
  v_mfma_f32_16x16x16_bf16 v[12:15], a[104:105], v[28:29], v[12:15]
  v_mfma_f32_16x16x16_bf16 v[16:19], a[106:107], v[28:29], v[16:19]
  v_mfma_f32_16x16x16_bf16 v[12:15], a[108:109], v[30:31], v[12:15]
  v_mfma_f32_16x16x16_bf16 v[16:19], a[110:111], v[30:31], v[16:19]
  v_mfma_f32_16x16x16_bf16 v[12:15], a[112:113], v[32:33], v[12:15]
  v_mfma_f32_16x16x16_bf16 v[16:19], a[114:115], v[32:33], v[16:19]
  v_mfma_f32_16x16x16_bf16 v[12:15], a[116:117], v[34:35], v[12:15]
  v_mfma_f32_16x16x16_bf16 v[16:19], a[118:119], v[34:35], v[16:19]
  v_mfma_f32_16x16x16_bf16 v[12:15], a[120:121], v[36:37], v[12:15]
  v_mfma_f32_16x16x16_bf16 v[16:19], a[122:123], v[36:37], v[16:19]
  v_mfma_f32_16x16x16_bf16 v[12:15], a[124:125], v[38:39], v[12:15]
  v_mfma_f32_16x16x16_bf16 v[16:19], a[126:127], v[38:39], v[16:19]
  s_cmp_lg_u32 s67, 0
  s_cbranch_scc1 L_half
  s_sub_u32 s69, s69, 1
  s_cbranch_scc0 L_sk1V
  s_mov_b32 s69, 0
  s_cmp_lt_u32 s58, 6
  s_cbranch_scc1 L_sk1Vd
  s_waitcnt vmcnt(4)
L_sk1Vd:
  v_mov_b32 v23, 1
  s_mov_b64 exec, 1
  buffer_atomic_add v23, v201, s[48:51], 0 offen sc0 sc1
  s_mov_b64 exec, -1
  buffer_load_dwordx4 a[160:163], v3, s[32:35], s57 offen nt
  s_add_u32 s59, s57, 4096
  buffer_load_dwordx4 a[164:167], v3, s[32:35], s59 offen nt
  s_add_u32 s59, s57, 8192
  buffer_load_dwordx4 a[168:171], v3, s[32:35], s59 offen nt
  s_add_u32 s59, s57, 12288
  buffer_load_dwordx4 a[172:175], v3, s[32:35], s59 offen nt
  s_add_u32 s59, s57, 16384
  buffer_load_dwordx4 a[176:179], v3, s[32:35], s59 offen nt
  s_add_u32 s59, s57, 20480
  buffer_load_dwordx4 a[180:183], v3, s[32:35], s59 offen nt
  s_add_u32 s59, s57, 24576
  buffer_load_dwordx4 a[184:187], v3, s[32:35], s59 offen nt
  s_add_u32 s59, s57, 28672
  buffer_load_dwordx4 a[188:191], v3, s[32:35], s59 offen nt
L_sk1V:
  s_sub_u32 s68, s68, 1
  s_cbranch_scc0 L_gwK2
  s_mov_b32 s68, 0
  s_waitcnt vmcnt(9)
L_gwK2:
  v_mfma_f32_16x16x32_bf16 v[40:43], a[128:131], v[8:11], 0
  v_mfma_f32_16x16x32_bf16 v[44:47], a[132:135], v[8:11], 0
  v_mfma_f32_16x16x32_bf16 v[48:51], a[136:139], v[8:11], 0
  v_mfma_f32_16x16x32_bf16 v[52:55], a[140:143], v[8:11], 0
  v_mfma_f32_16x16x32_bf16 v[56:59], a[144:147], v[8:11], 0
  v_mfma_f32_16x16x32_bf16 v[60:63], a[148:151], v[8:11], 0
  v_mfma_f32_16x16x32_bf16 v[64:67], a[152:155], v[8:11], 0
  v_mfma_f32_16x16x32_bf16 v[68:71], a[156:159], v[8:11], 0
  s_add_u32 s58, s58, 1
  s_add_u32 s57, s57, 0x8000
  s_cmp_ge_u32 s58, 13
  s_cselect_b32 s50, 8388608, 0
  v_mov_b32_dpp v76, v40 quad_perm:[0,1,2,3] row_mask:0xf bank_mask:0x1
  v_mov_b32_dpp v77, v42 row_ror:8 row_mask:0xf bank_mask:0x1
  v_mov_b32_dpp v78, v56 quad_perm:[0,1,2,3] row_mask:0xf bank_mask:0x1
  v_mov_b32_dpp v79, v58 row_ror:8 row_mask:0xf bank_mask:0x1
  v_mov_b32_dpp v76, v44 row_ror:4 row_mask:0xf bank_mask:0x2
  v_mov_b32_dpp v77, v46 row_ror:12 row_mask:0xf bank_mask:0x2
  v_mov_b32_dpp v78, v60 row_ror:4 row_mask:0xf bank_mask:0x2
  v_mov_b32_dpp v79, v62 row_ror:12 row_mask:0xf bank_mask:0x2
  v_mov_b32_dpp v76, v48 row_ror:8 row_mask:0xf bank_mask:0x4
  v_mov_b32_dpp v77, v50 quad_perm:[0,1,2,3] row_mask:0xf bank_mask:0x4
  v_mov_b32_dpp v78, v64 row_ror:8 row_mask:0xf bank_mask:0x4
  v_mov_b32_dpp v79, v66 quad_perm:[0,1,2,3] row_mask:0xf bank_mask:0x4
  v_mov_b32_dpp v76, v52 row_ror:12 row_mask:0xf bank_mask:0x8
  v_mov_b32_dpp v77, v54 row_ror:4 row_mask:0xf bank_mask:0x8
  v_mov_b32_dpp v78, v68 row_ror:12 row_mask:0xf bank_mask:0x8
  v_mov_b32_dpp v79, v70 row_ror:4 row_mask:0xf bank_mask:0x8
  v_add_f32_dpp v76, v41, v76 row_ror:12 row_mask:0xf bank_mask:0x1
  v_add_f32_dpp v77, v43, v77 row_ror:4 row_mask:0xf bank_mask:0x1
  v_add_f32_dpp v78, v57, v78 row_ror:12 row_mask:0xf bank_mask:0x1
  v_add_f32_dpp v79, v59, v79 row_ror:4 row_mask:0xf bank_mask:0x1
  v_add_f32_dpp v76, v45, v76 quad_perm:[0,1,2,3] row_mask:0xf bank_mask:0x2
  v_add_f32_dpp v77, v47, v77 row_ror:8 row_mask:0xf bank_mask:0x2
  v_add_f32_dpp v78, v61, v78 quad_perm:[0,1,2,3] row_mask:0xf bank_mask:0x2
  v_add_f32_dpp v79, v63, v79 row_ror:8 row_mask:0xf bank_mask:0x2
  v_add_f32_dpp v76, v49, v76 row_ror:4 row_mask:0xf bank_mask:0x4
  v_add_f32_dpp v77, v51, v77 row_ror:12 row_mask:0xf bank_mask:0x4
  v_add_f32_dpp v78, v65, v78 row_ror:4 row_mask:0xf bank_mask:0x4
  v_add_f32_dpp v79, v67, v79 row_ror:12 row_mask:0xf bank_mask:0x4
  v_add_f32_dpp v76, v53, v76 row_ror:8 row_mask:0xf bank_mask:0x8
  v_add_f32_dpp v77, v55, v77 quad_perm:[0,1,2,3] row_mask:0xf bank_mask:0x8
  v_add_f32_dpp v78, v69, v78 row_ror:8 row_mask:0xf bank_mask:0x8
  v_add_f32_dpp v79, v71, v79 quad_perm:[0,1,2,3] row_mask:0xf bank_mask:0x8
  v_add_f32 v72, v76, v77
  v_add_f32 v73, v78, v79
  v_cvt_pk_bf16_f32 v74, v72, v73
  v_lshlrev_b32 v72, 16, v74
  v_and_b32 v73, 0xffff0000, v74
  v_mul_f32 v72, 0x3db504f3, v72
  v_mul_f32 v73, 0x3db504f3, v73
  v_cvt_pk_bf16_f32 v74, v72, v73
  v_lshlrev_b32 v72, 16, v74
  v_and_b32 v73, 0xffff0000, v74
  v_max_f32 v84, v72, v73
  v_cmp_gt_f32 vcc, v84, v22
  s_cbranch_vccz L_nors2
  v_max_f32_dpp v84, v84, v84 row_ror:4 row_mask:0xf bank_mask:0xf
  s_nop 1
  v_max_f32_dpp v84, v84, v84 row_ror:8 row_mask:0xf bank_mask:0xf
  v_mov_b32 v85, v84
  s_nop 1
  v_permlane16_swap_b32 v84, v85
  v_max_f32 v84, v84, v85
  v_mov_b32 v85, v84
  s_nop 1
  v_permlane32_swap_b32 v84, v85
  v_max_f32 v84, v84, v85
  v_max_f32 v84, v84, v22
  v_sub_f32 v85, v22, v84
  v_mul_f32 v85, 0x3fb8aa3b, v85
  v_exp_f32 v85, v85
  v_mov_b32 v22, v84
  v_mul_f32 v20, 0xbfb8aa3b, v84
  v_mul_f32 v21, v21, v85
  v_mul_f32 v12, v12, v85
  v_mul_f32 v13, v13, v85
  v_mul_f32 v14, v14, v85
  v_mul_f32 v15, v15, v85
  v_mul_f32 v16, v16, v85
  v_mul_f32 v17, v17, v85
  v_mul_f32 v18, v18, v85
  v_mul_f32 v19, v19, v85
L_nors2:
  v_fma_f32 v72, v72, s73, v20
  v_fma_f32 v73, v73, s73, v20
  v_exp_f32 v72, v72
  v_exp_f32 v73, v73
  v_add_f32 v21, v21, v72
  v_cvt_pk_bf16_f32 v74, v72, v73
  v_add_f32 v21, v21, v73
  v_and_b32 v80, 0xffff, v74
  v_lshlrev_b32 v81, 16, v74
  v_lshrrev_b32 v82, 16, v74
  v_and_b32 v83, 0xffff0000, v74
  v_mov_b32_dpp v24, v80 quad_perm:[0,1,2,3] row_mask:0xf bank_mask:0x1
  v_mov_b32_dpp v25, v80 row_ror:8 row_mask:0xf bank_mask:0x4
  v_mov_b32_dpp v26, v80 row_ror:12 row_mask:0xf bank_mask:0x1
  v_mov_b32_dpp v27, v80 row_ror:4 row_mask:0xf bank_mask:0x4
  v_mov_b32_dpp v24, v81 row_ror:4 row_mask:0xf bank_mask:0x2
  v_mov_b32_dpp v25, v81 row_ror:12 row_mask:0xf bank_mask:0x8
  v_mov_b32_dpp v26, v81 quad_perm:[0,1,2,3] row_mask:0xf bank_mask:0x2
  v_mov_b32_dpp v27, v81 row_ror:8 row_mask:0xf bank_mask:0x8
  v_mov_b32_dpp v28, v80 row_ror:8 row_mask:0xf bank_mask:0x1
  v_mov_b32_dpp v29, v80 quad_perm:[0,1,2,3] row_mask:0xf bank_mask:0x4
  v_mov_b32_dpp v30, v80 row_ror:4 row_mask:0xf bank_mask:0x1
  v_mov_b32_dpp v31, v80 row_ror:12 row_mask:0xf bank_mask:0x4
  v_mov_b32_dpp v28, v81 row_ror:12 row_mask:0xf bank_mask:0x2
  v_mov_b32_dpp v29, v81 row_ror:4 row_mask:0xf bank_mask:0x8
  v_mov_b32_dpp v30, v81 row_ror:8 row_mask:0xf bank_mask:0x2
  v_mov_b32_dpp v31, v81 quad_perm:[0,1,2,3] row_mask:0xf bank_mask:0x8
  v_mov_b32_dpp v32, v82 quad_perm:[0,1,2,3] row_mask:0xf bank_mask:0x1
  v_mov_b32_dpp v33, v82 row_ror:8 row_mask:0xf bank_mask:0x4
  v_mov_b32_dpp v34, v82 row_ror:12 row_mask:0xf bank_mask:0x1
  v_mov_b32_dpp v35, v82 row_ror:4 row_mask:0xf bank_mask:0x4
  v_mov_b32_dpp v32, v83 row_ror:4 row_mask:0xf bank_mask:0x2
  v_mov_b32_dpp v33, v83 row_ror:12 row_mask:0xf bank_mask:0x8
  v_mov_b32_dpp v34, v83 quad_perm:[0,1,2,3] row_mask:0xf bank_mask:0x2
  v_mov_b32_dpp v35, v83 row_ror:8 row_mask:0xf bank_mask:0x8
  v_mov_b32_dpp v36, v82 row_ror:8 row_mask:0xf bank_mask:0x1
  v_mov_b32_dpp v37, v82 quad_perm:[0,1,2,3] row_mask:0xf bank_mask:0x4
  v_mov_b32_dpp v38, v82 row_ror:4 row_mask:0xf bank_mask:0x1
  v_mov_b32_dpp v39, v82 row_ror:12 row_mask:0xf bank_mask:0x4
  v_mov_b32_dpp v36, v83 row_ror:12 row_mask:0xf bank_mask:0x2
  v_mov_b32_dpp v37, v83 row_ror:4 row_mask:0xf bank_mask:0x8
  v_mov_b32_dpp v38, v83 row_ror:8 row_mask:0xf bank_mask:0x2
  v_mov_b32_dpp v39, v83 quad_perm:[0,1,2,3] row_mask:0xf bank_mask:0x8
  s_sub_u32 s69, s69, 1
  s_cbranch_scc0 L_sk2K
  s_mov_b32 s69, 0
  s_cmp_lt_u32 s58, 6
  s_cbranch_scc1 L_st2
  s_waitcnt vmcnt(4)
  s_cmp_lt_u32 s58, 14
  s_cbranch_scc1 L_st2
  v_readfirstlane_b32 s59, v23
  s_and_b32 s57, s59, 7
  s_add_u32 s65, s59, s77
  s_and_b32 s65, s65, 3
  s_lshl3_add_u32 s57, s65, s57
  s_lshl_b32 s57, s57, 19
  s_lshr_b32 s65, s59, 3
  s_min_u32 s72, s65, 1
  s_add_u32 s65, s65, s72
  s_add_u32 s65, s65, 28
  s_lshl_b32 s65, s65, 14
  s_add_u32 s57, s57, s65
  s_cmp_lt_u32 s59, 8
  s_cbranch_scc1 L_st2
  s_mov_b32 s67, 3
  s_cmp_ge_u32 s59, 24
  s_cbranch_scc1 L_fl2
  s_cmp_ge_u32 s59, s79
  s_cselect_b32 s67, 1, 2
  s_cselect_b32 s50, 0, 8388608
  buffer_load_dwordx4 v[88:91], v2, s[28:31], s57 offen nt
  s_add_u32 s59, s57, 4096
  buffer_load_dwordx4 v[92:95], v2, s[28:31], s59 offen nt
  s_add_u32 s59, s57, 8192
  buffer_load_dwordx4 v[96:99], v2, s[28:31], s59 offen nt
  s_add_u32 s59, s57, 12288
  buffer_load_dwordx4 v[100:103], v2, s[28:31], s59 offen nt
  buffer_load_dwordx4 v[104:107], v3, s[32:35], s57 offen nt
  s_add_u32 s59, s57, 4096
  buffer_load_dwordx4 v[108:111], v3, s[32:35], s59 offen nt
  s_add_u32 s59, s57, 8192
  buffer_load_dwordx4 v[112:115], v3, s[32:35], s59 offen nt
  s_add_u32 s59, s57, 12288
  buffer_load_dwordx4 v[116:119], v3, s[32:35], s59 offen nt
  v_mov_b32 v23, 1
  s_mov_b64 exec, 1
  buffer_atomic_add v23, v201, s[48:51], 0 offen sc0 sc1
  s_mov_b64 exec, -1
  s_waitcnt vmcnt(9)
  s_branch L_gwV2
L_fl2:
  s_waitcnt vmcnt(0)
  s_branch L_gwV2
L_st2:
  buffer_load_dwordx4 a[192:195], v2, s[28:31], s57 offen nt
  s_add_u32 s59, s57, 4096
  buffer_load_dwordx4 a[196:199], v2, s[28:31], s59 offen nt
  s_add_u32 s59, s57, 8192
  buffer_load_dwordx4 a[200:203], v2, s[28:31], s59 offen nt
  s_add_u32 s59, s57, 12288
  buffer_load_dwordx4 a[204:207], v2, s[28:31], s59 offen nt
  s_add_u32 s59, s57, 16384
  buffer_load_dwordx4 a[208:211], v2, s[28:31], s59 offen nt
  s_add_u32 s59, s57, 20480
  buffer_load_dwordx4 a[212:215], v2, s[28:31], s59 offen nt
  s_add_u32 s59, s57, 24576
  buffer_load_dwordx4 a[216:219], v2, s[28:31], s59 offen nt
  s_add_u32 s59, s57, 28672
  buffer_load_dwordx4 a[220:223], v2, s[28:31], s59 offen nt
L_sk2K:
  s_sub_u32 s68, s68, 1
  s_cbranch_scc0 L_gwV2
  s_mov_b32 s68, 0
  s_waitcnt vmcnt(8)
L_gwV2:
  v_mfma_f32_16x16x16_bf16 v[12:15], a[160:161], v[24:25], v[12:15]
  v_mfma_f32_16x16x16_bf16 v[16:19], a[162:163], v[24:25], v[16:19]
  v_mfma_f32_16x16x16_bf16 v[12:15], a[164:165], v[26:27], v[12:15]
  v_mfma_f32_16x16x16_bf16 v[16:19], a[166:167], v[26:27], v[16:19]
  v_mfma_f32_16x16x16_bf16 v[12:15], a[168:169], v[28:29], v[12:15]
  v_mfma_f32_16x16x16_bf16 v[16:19], a[170:171], v[28:29], v[16:19]
  v_mfma_f32_16x16x16_bf16 v[12:15], a[172:173], v[30:31], v[12:15]
  v_mfma_f32_16x16x16_bf16 v[16:19], a[174:175], v[30:31], v[16:19]
  v_mfma_f32_16x16x16_bf16 v[12:15], a[176:177], v[32:33], v[12:15]
  v_mfma_f32_16x16x16_bf16 v[16:19], a[178:179], v[32:33], v[16:19]
  v_mfma_f32_16x16x16_bf16 v[12:15], a[180:181], v[34:35], v[12:15]
  v_mfma_f32_16x16x16_bf16 v[16:19], a[182:183], v[34:35], v[16:19]
  v_mfma_f32_16x16x16_bf16 v[12:15], a[184:185], v[36:37], v[12:15]
  v_mfma_f32_16x16x16_bf16 v[16:19], a[186:187], v[36:37], v[16:19]
  v_mfma_f32_16x16x16_bf16 v[12:15], a[188:189], v[38:39], v[12:15]
  v_mfma_f32_16x16x16_bf16 v[16:19], a[190:191], v[38:39], v[16:19]
  s_cmp_lg_u32 s67, 0
  s_cbranch_scc1 L_half
  s_sub_u32 s69, s69, 1
  s_cbranch_scc0 L_sk2V
  s_mov_b32 s69, 0
  s_cmp_lt_u32 s58, 6
  s_cbranch_scc1 L_sk2Vd
  s_waitcnt vmcnt(4)
L_sk2Vd:
  v_mov_b32 v23, 1
  s_mov_b64 exec, 1
  buffer_atomic_add v23, v201, s[48:51], 0 offen sc0 sc1
  s_mov_b64 exec, -1
  buffer_load_dwordx4 a[224:227], v3, s[32:35], s57 offen nt
  s_add_u32 s59, s57, 4096
  buffer_load_dwordx4 a[228:231], v3, s[32:35], s59 offen nt
  s_add_u32 s59, s57, 8192
  buffer_load_dwordx4 a[232:235], v3, s[32:35], s59 offen nt
  s_add_u32 s59, s57, 12288
  buffer_load_dwordx4 a[236:239], v3, s[32:35], s59 offen nt
  s_add_u32 s59, s57, 16384
  buffer_load_dwordx4 a[240:243], v3, s[32:35], s59 offen nt
  s_add_u32 s59, s57, 20480
  buffer_load_dwordx4 a[244:247], v3, s[32:35], s59 offen nt
  s_add_u32 s59, s57, 24576
  buffer_load_dwordx4 a[248:251], v3, s[32:35], s59 offen nt
  s_add_u32 s59, s57, 28672
  buffer_load_dwordx4 a[252:255], v3, s[32:35], s59 offen nt
L_sk2V:
  s_sub_u32 s68, s68, 1
  s_cbranch_scc0 L_gwK3
  s_mov_b32 s68, 0
  s_waitcnt vmcnt(9)
L_gwK3:
  v_mfma_f32_16x16x32_bf16 v[40:43], a[192:195], v[8:11], 0
  v_mfma_f32_16x16x32_bf16 v[44:47], a[196:199], v[8:11], 0
  v_mfma_f32_16x16x32_bf16 v[48:51], a[200:203], v[8:11], 0
  v_mfma_f32_16x16x32_bf16 v[52:55], a[204:207], v[8:11], 0
  v_mfma_f32_16x16x32_bf16 v[56:59], a[208:211], v[8:11], 0
  v_mfma_f32_16x16x32_bf16 v[60:63], a[212:215], v[8:11], 0
  v_mfma_f32_16x16x32_bf16 v[64:67], a[216:219], v[8:11], 0
  v_mfma_f32_16x16x32_bf16 v[68:71], a[220:223], v[8:11], 0
  s_add_u32 s58, s58, 1
  s_add_u32 s57, s57, 0x8000
  s_cmp_ge_u32 s58, 13
  s_cselect_b32 s50, 8388608, 0
  v_mov_b32_dpp v76, v40 quad_perm:[0,1,2,3] row_mask:0xf bank_mask:0x1
  v_mov_b32_dpp v77, v42 row_ror:8 row_mask:0xf bank_mask:0x1
  v_mov_b32_dpp v78, v56 quad_perm:[0,1,2,3] row_mask:0xf bank_mask:0x1
  v_mov_b32_dpp v79, v58 row_ror:8 row_mask:0xf bank_mask:0x1
  v_mov_b32_dpp v76, v44 row_ror:4 row_mask:0xf bank_mask:0x2
  v_mov_b32_dpp v77, v46 row_ror:12 row_mask:0xf bank_mask:0x2
  v_mov_b32_dpp v78, v60 row_ror:4 row_mask:0xf bank_mask:0x2
  v_mov_b32_dpp v79, v62 row_ror:12 row_mask:0xf bank_mask:0x2
  v_mov_b32_dpp v76, v48 row_ror:8 row_mask:0xf bank_mask:0x4
  v_mov_b32_dpp v77, v50 quad_perm:[0,1,2,3] row_mask:0xf bank_mask:0x4
  v_mov_b32_dpp v78, v64 row_ror:8 row_mask:0xf bank_mask:0x4
  v_mov_b32_dpp v79, v66 quad_perm:[0,1,2,3] row_mask:0xf bank_mask:0x4
  v_mov_b32_dpp v76, v52 row_ror:12 row_mask:0xf bank_mask:0x8
  v_mov_b32_dpp v77, v54 row_ror:4 row_mask:0xf bank_mask:0x8
  v_mov_b32_dpp v78, v68 row_ror:12 row_mask:0xf bank_mask:0x8
  v_mov_b32_dpp v79, v70 row_ror:4 row_mask:0xf bank_mask:0x8
  v_add_f32_dpp v76, v41, v76 row_ror:12 row_mask:0xf bank_mask:0x1
  v_add_f32_dpp v77, v43, v77 row_ror:4 row_mask:0xf bank_mask:0x1
  v_add_f32_dpp v78, v57, v78 row_ror:12 row_mask:0xf bank_mask:0x1
  v_add_f32_dpp v79, v59, v79 row_ror:4 row_mask:0xf bank_mask:0x1
  v_add_f32_dpp v76, v45, v76 quad_perm:[0,1,2,3] row_mask:0xf bank_mask:0x2
  v_add_f32_dpp v77, v47, v77 row_ror:8 row_mask:0xf bank_mask:0x2
  v_add_f32_dpp v78, v61, v78 quad_perm:[0,1,2,3] row_mask:0xf bank_mask:0x2
  v_add_f32_dpp v79, v63, v79 row_ror:8 row_mask:0xf bank_mask:0x2
  v_add_f32_dpp v76, v49, v76 row_ror:4 row_mask:0xf bank_mask:0x4
  v_add_f32_dpp v77, v51, v77 row_ror:12 row_mask:0xf bank_mask:0x4
  v_add_f32_dpp v78, v65, v78 row_ror:4 row_mask:0xf bank_mask:0x4
  v_add_f32_dpp v79, v67, v79 row_ror:12 row_mask:0xf bank_mask:0x4
  v_add_f32_dpp v76, v53, v76 row_ror:8 row_mask:0xf bank_mask:0x8
  v_add_f32_dpp v77, v55, v77 quad_perm:[0,1,2,3] row_mask:0xf bank_mask:0x8
  v_add_f32_dpp v78, v69, v78 row_ror:8 row_mask:0xf bank_mask:0x8
  v_add_f32_dpp v79, v71, v79 quad_perm:[0,1,2,3] row_mask:0xf bank_mask:0x8
  v_add_f32 v72, v76, v77
  v_add_f32 v73, v78, v79
  v_cvt_pk_bf16_f32 v74, v72, v73
  v_lshlrev_b32 v72, 16, v74
  v_and_b32 v73, 0xffff0000, v74
  v_mul_f32 v72, 0x3db504f3, v72
  v_mul_f32 v73, 0x3db504f3, v73
  v_cvt_pk_bf16_f32 v74, v72, v73
  v_lshlrev_b32 v72, 16, v74
  v_and_b32 v73, 0xffff0000, v74
  v_max_f32 v84, v72, v73
  v_cmp_gt_f32 vcc, v84, v22
  s_cbranch_vccz L_nors3
  v_max_f32_dpp v84, v84, v84 row_ror:4 row_mask:0xf bank_mask:0xf
  s_nop 1
  v_max_f32_dpp v84, v84, v84 row_ror:8 row_mask:0xf bank_mask:0xf
  v_mov_b32 v85, v84
  s_nop 1
  v_permlane16_swap_b32 v84, v85
  v_max_f32 v84, v84, v85
  v_mov_b32 v85, v84
  s_nop 1
  v_permlane32_swap_b32 v84, v85
  v_max_f32 v84, v84, v85
  v_max_f32 v84, v84, v22
  v_sub_f32 v85, v22, v84
  v_mul_f32 v85, 0x3fb8aa3b, v85
  v_exp_f32 v85, v85
  v_mov_b32 v22, v84
  v_mul_f32 v20, 0xbfb8aa3b, v84
  v_mul_f32 v21, v21, v85
  v_mul_f32 v12, v12, v85
  v_mul_f32 v13, v13, v85
  v_mul_f32 v14, v14, v85
  v_mul_f32 v15, v15, v85
  v_mul_f32 v16, v16, v85
  v_mul_f32 v17, v17, v85
  v_mul_f32 v18, v18, v85
  v_mul_f32 v19, v19, v85
L_nors3:
  v_fma_f32 v72, v72, s73, v20
  v_fma_f32 v73, v73, s73, v20
  v_exp_f32 v72, v72
  v_exp_f32 v73, v73
  v_add_f32 v21, v21, v72
  v_cvt_pk_bf16_f32 v74, v72, v73
  v_add_f32 v21, v21, v73
  v_and_b32 v80, 0xffff, v74
  v_lshlrev_b32 v81, 16, v74
  v_lshrrev_b32 v82, 16, v74
  v_and_b32 v83, 0xffff0000, v74
  v_mov_b32_dpp v24, v80 quad_perm:[0,1,2,3] row_mask:0xf bank_mask:0x1
  v_mov_b32_dpp v25, v80 row_ror:8 row_mask:0xf bank_mask:0x4
  v_mov_b32_dpp v26, v80 row_ror:12 row_mask:0xf bank_mask:0x1
  v_mov_b32_dpp v27, v80 row_ror:4 row_mask:0xf bank_mask:0x4
  v_mov_b32_dpp v24, v81 row_ror:4 row_mask:0xf bank_mask:0x2
  v_mov_b32_dpp v25, v81 row_ror:12 row_mask:0xf bank_mask:0x8
  v_mov_b32_dpp v26, v81 quad_perm:[0,1,2,3] row_mask:0xf bank_mask:0x2
  v_mov_b32_dpp v27, v81 row_ror:8 row_mask:0xf bank_mask:0x8
  v_mov_b32_dpp v28, v80 row_ror:8 row_mask:0xf bank_mask:0x1
  v_mov_b32_dpp v29, v80 quad_perm:[0,1,2,3] row_mask:0xf bank_mask:0x4
  v_mov_b32_dpp v30, v80 row_ror:4 row_mask:0xf bank_mask:0x1
  v_mov_b32_dpp v31, v80 row_ror:12 row_mask:0xf bank_mask:0x4
  v_mov_b32_dpp v28, v81 row_ror:12 row_mask:0xf bank_mask:0x2
  v_mov_b32_dpp v29, v81 row_ror:4 row_mask:0xf bank_mask:0x8
  v_mov_b32_dpp v30, v81 row_ror:8 row_mask:0xf bank_mask:0x2
  v_mov_b32_dpp v31, v81 quad_perm:[0,1,2,3] row_mask:0xf bank_mask:0x8
  v_mov_b32_dpp v32, v82 quad_perm:[0,1,2,3] row_mask:0xf bank_mask:0x1
  v_mov_b32_dpp v33, v82 row_ror:8 row_mask:0xf bank_mask:0x4
  v_mov_b32_dpp v34, v82 row_ror:12 row_mask:0xf bank_mask:0x1
  v_mov_b32_dpp v35, v82 row_ror:4 row_mask:0xf bank_mask:0x4
  v_mov_b32_dpp v32, v83 row_ror:4 row_mask:0xf bank_mask:0x2
  v_mov_b32_dpp v33, v83 row_ror:12 row_mask:0xf bank_mask:0x8
  v_mov_b32_dpp v34, v83 quad_perm:[0,1,2,3] row_mask:0xf bank_mask:0x2
  v_mov_b32_dpp v35, v83 row_ror:8 row_mask:0xf bank_mask:0x8
  v_mov_b32_dpp v36, v82 row_ror:8 row_mask:0xf bank_mask:0x1
  v_mov_b32_dpp v37, v82 quad_perm:[0,1,2,3] row_mask:0xf bank_mask:0x4
  v_mov_b32_dpp v38, v82 row_ror:4 row_mask:0xf bank_mask:0x1
  v_mov_b32_dpp v39, v82 row_ror:12 row_mask:0xf bank_mask:0x4
  v_mov_b32_dpp v36, v83 row_ror:12 row_mask:0xf bank_mask:0x2
  v_mov_b32_dpp v37, v83 row_ror:4 row_mask:0xf bank_mask:0x8
  v_mov_b32_dpp v38, v83 row_ror:8 row_mask:0xf bank_mask:0x2
  v_mov_b32_dpp v39, v83 quad_perm:[0,1,2,3] row_mask:0xf bank_mask:0x8
  s_sub_u32 s69, s69, 1
  s_cbranch_scc0 L_sk3K
  s_mov_b32 s69, 0
  s_cmp_lt_u32 s58, 6
  s_cbranch_scc1 L_st3
  s_waitcnt vmcnt(4)
  s_cmp_lt_u32 s58, 14
  s_cbranch_scc1 L_st3
  v_readfirstlane_b32 s59, v23
  s_and_b32 s57, s59, 7
  s_add_u32 s65, s59, s77
  s_and_b32 s65, s65, 3
  s_lshl3_add_u32 s57, s65, s57
  s_lshl_b32 s57, s57, 19
  s_lshr_b32 s65, s59, 3
  s_min_u32 s72, s65, 1
  s_add_u32 s65, s65, s72
  s_add_u32 s65, s65, 28
  s_lshl_b32 s65, s65, 14
  s_add_u32 s57, s57, s65
  s_cmp_lt_u32 s59, 8
  s_cbranch_scc1 L_st3
  s_mov_b32 s67, 3
  s_cmp_ge_u32 s59, 24
  s_cbranch_scc1 L_fl3
  s_cmp_ge_u32 s59, s79
  s_cselect_b32 s67, 1, 2
  s_cselect_b32 s50, 0, 8388608
  buffer_load_dwordx4 v[88:91], v2, s[28:31], s57 offen nt
  s_add_u32 s59, s57, 4096
  buffer_load_dwordx4 v[92:95], v2, s[28:31], s59 offen nt
  s_add_u32 s59, s57, 8192
  buffer_load_dwordx4 v[96:99], v2, s[28:31], s59 offen nt
  s_add_u32 s59, s57, 12288
  buffer_load_dwordx4 v[100:103], v2, s[28:31], s59 offen nt
  buffer_load_dwordx4 v[104:107], v3, s[32:35], s57 offen nt
  s_add_u32 s59, s57, 4096
  buffer_load_dwordx4 v[108:111], v3, s[32:35], s59 offen nt
  s_add_u32 s59, s57, 8192
  buffer_load_dwordx4 v[112:115], v3, s[32:35], s59 offen nt
  s_add_u32 s59, s57, 12288
  buffer_load_dwordx4 v[116:119], v3, s[32:35], s59 offen nt
  v_mov_b32 v23, 1
  s_mov_b64 exec, 1
  buffer_atomic_add v23, v201, s[48:51], 0 offen sc0 sc1
  s_mov_b64 exec, -1
  s_waitcnt vmcnt(9)
  s_branch L_gwV3
L_fl3:
  s_waitcnt vmcnt(0)
  s_branch L_gwV3
L_st3:
  buffer_load_dwordx4 a[0:3], v2, s[28:31], s57 offen nt
  s_add_u32 s59, s57, 4096
  buffer_load_dwordx4 a[4:7], v2, s[28:31], s59 offen nt
  s_add_u32 s59, s57, 8192
  buffer_load_dwordx4 a[8:11], v2, s[28:31], s59 offen nt
  s_add_u32 s59, s57, 12288
  buffer_load_dwordx4 a[12:15], v2, s[28:31], s59 offen nt
  s_add_u32 s59, s57, 16384
  buffer_load_dwordx4 a[16:19], v2, s[28:31], s59 offen nt
  s_add_u32 s59, s57, 20480
  buffer_load_dwordx4 a[20:23], v2, s[28:31], s59 offen nt
  s_add_u32 s59, s57, 24576
  buffer_load_dwordx4 a[24:27], v2, s[28:31], s59 offen nt
  s_add_u32 s59, s57, 28672
  buffer_load_dwordx4 a[28:31], v2, s[28:31], s59 offen nt
L_sk3K:
  s_sub_u32 s68, s68, 1
  s_cbranch_scc0 L_gwV3
  s_mov_b32 s68, 0
  s_waitcnt vmcnt(8)
L_gwV3:
  v_mfma_f32_16x16x16_bf16 v[12:15], a[224:225], v[24:25], v[12:15]
  v_mfma_f32_16x16x16_bf16 v[16:19], a[226:227], v[24:25], v[16:19]
  v_mfma_f32_16x16x16_bf16 v[12:15], a[228:229], v[26:27], v[12:15]
  v_mfma_f32_16x16x16_bf16 v[16:19], a[230:231], v[26:27], v[16:19]
  v_mfma_f32_16x16x16_bf16 v[12:15], a[232:233], v[28:29], v[12:15]
  v_mfma_f32_16x16x16_bf16 v[16:19], a[234:235], v[28:29], v[16:19]
  v_mfma_f32_16x16x16_bf16 v[12:15], a[236:237], v[30:31], v[12:15]
  v_mfma_f32_16x16x16_bf16 v[16:19], a[238:239], v[30:31], v[16:19]
  v_mfma_f32_16x16x16_bf16 v[12:15], a[240:241], v[32:33], v[12:15]
  v_mfma_f32_16x16x16_bf16 v[16:19], a[242:243], v[32:33], v[16:19]
  v_mfma_f32_16x16x16_bf16 v[12:15], a[244:245], v[34:35], v[12:15]
  v_mfma_f32_16x16x16_bf16 v[16:19], a[246:247], v[34:35], v[16:19]
  v_mfma_f32_16x16x16_bf16 v[12:15], a[248:249], v[36:37], v[12:15]
  v_mfma_f32_16x16x16_bf16 v[16:19], a[250:251], v[36:37], v[16:19]
  v_mfma_f32_16x16x16_bf16 v[12:15], a[252:253], v[38:39], v[12:15]
  v_mfma_f32_16x16x16_bf16 v[16:19], a[254:255], v[38:39], v[16:19]
  s_cmp_lg_u32 s67, 0
  s_cbranch_scc1 L_half
  s_sub_u32 s69, s69, 1
  s_cbranch_scc0 L_sk3V
  s_mov_b32 s69, 0
  s_cmp_lt_u32 s58, 6
  s_cbranch_scc1 L_sk3Vd
  s_waitcnt vmcnt(4)
L_sk3Vd:
  v_mov_b32 v23, 1
  s_mov_b64 exec, 1
  buffer_atomic_add v23, v201, s[48:51], 0 offen sc0 sc1
  s_mov_b64 exec, -1
  buffer_load_dwordx4 a[32:35], v3, s[32:35], s57 offen nt
  s_add_u32 s59, s57, 4096
  buffer_load_dwordx4 a[36:39], v3, s[32:35], s59 offen nt
  s_add_u32 s59, s57, 8192
  buffer_load_dwordx4 a[40:43], v3, s[32:35], s59 offen nt
  s_add_u32 s59, s57, 12288
  buffer_load_dwordx4 a[44:47], v3, s[32:35], s59 offen nt
  s_add_u32 s59, s57, 16384
  buffer_load_dwordx4 a[48:51], v3, s[32:35], s59 offen nt
  s_add_u32 s59, s57, 20480
  buffer_load_dwordx4 a[52:55], v3, s[32:35], s59 offen nt
  s_add_u32 s59, s57, 24576
  buffer_load_dwordx4 a[56:59], v3, s[32:35], s59 offen nt
  s_add_u32 s59, s57, 28672
  buffer_load_dwordx4 a[60:63], v3, s[32:35], s59 offen nt
L_sk3V:
  s_nop 3
  s_branch L_loop
L_hnext:
  s_waitcnt vmcnt(0)
  v_readfirstlane_b32 s59, v23
  s_and_b32 s57, s59, 7
  s_add_u32 s65, s59, s77
  s_and_b32 s65, s65, 3
  s_lshl3_add_u32 s57, s65, s57
  s_lshl_b32 s57, s57, 19
  s_lshr_b32 s65, s59, 3
  s_min_u32 s72, s65, 1
  s_add_u32 s65, s65, s72
  s_add_u32 s65, s65, 28
  s_lshl_b32 s65, s65, 14
  s_add_u32 s57, s57, s65
  s_cmp_ge_u32 s59, 24
  s_cbranch_scc1 L_done
  s_cmp_ge_u32 s59, s79
  s_cselect_b32 s67, 1, 2
  s_cselect_b32 s50, 0, 8388608
  buffer_load_dwordx4 v[88:91], v2, s[28:31], s57 offen nt
  s_add_u32 s59, s57, 4096
  buffer_load_dwordx4 v[92:95], v2, s[28:31], s59 offen nt
  s_add_u32 s59, s57, 8192
  buffer_load_dwordx4 v[96:99], v2, s[28:31], s59 offen nt
  s_add_u32 s59, s57, 12288
  buffer_load_dwordx4 v[100:103], v2, s[28:31], s59 offen nt
  buffer_load_dwordx4 v[104:107], v3, s[32:35], s57 offen nt
  s_add_u32 s59, s57, 4096
  buffer_load_dwordx4 v[108:111], v3, s[32:35], s59 offen nt
  s_add_u32 s59, s57, 8192
  buffer_load_dwordx4 v[112:115], v3, s[32:35], s59 offen nt
  s_add_u32 s59, s57, 12288
  buffer_load_dwordx4 v[116:119], v3, s[32:35], s59 offen nt
  v_mov_b32 v23, 1
  s_mov_b64 exec, 1
  buffer_atomic_add v23, v201, s[48:51], 0 offen sc0 sc1
  s_mov_b64 exec, -1
L_half:
  s_cmp_eq_u32 s67, 3
  s_cbranch_scc1 L_done
  s_waitcnt vmcnt(5)
  v_mfma_f32_16x16x32_bf16 v[40:43], v[88:91], v[8:11], 0
  v_mfma_f32_16x16x32_bf16 v[44:47], v[92:95], v[8:11], 0
  v_mfma_f32_16x16x32_bf16 v[48:51], v[96:99], v[8:11], 0
  v_mfma_f32_16x16x32_bf16 v[52:55], v[100:103], v[8:11], 0
  s_nop 4
  v_mov_b32_dpp v76, v40 quad_perm:[0,1,2,3] row_mask:0xf bank_mask:0x1
  v_mov_b32_dpp v77, v42 row_ror:8 row_mask:0xf bank_mask:0x1
  s_nop 0
  v_mov_b32_dpp v76, v44 row_ror:4 row_mask:0xf bank_mask:0x2
  v_mov_b32_dpp v77, v46 row_ror:12 row_mask:0xf bank_mask:0x2
  s_nop 0
  v_mov_b32_dpp v76, v48 row_ror:8 row_mask:0xf bank_mask:0x4
  v_mov_b32_dpp v77, v50 quad_perm:[0,1,2,3] row_mask:0xf bank_mask:0x4
  s_nop 0
  v_mov_b32_dpp v76, v52 row_ror:12 row_mask:0xf bank_mask:0x8
  v_mov_b32_dpp v77, v54 row_ror:4 row_mask:0xf bank_mask:0x8
  s_nop 0
  v_add_f32_dpp v76, v41, v76 row_ror:12 row_mask:0xf bank_mask:0x1
  v_add_f32_dpp v77, v43, v77 row_ror:4 row_mask:0xf bank_mask:0x1
  s_nop 0
  v_add_f32_dpp v76, v45, v76 quad_perm:[0,1,2,3] row_mask:0xf bank_mask:0x2
  v_add_f32_dpp v77, v47, v77 row_ror:8 row_mask:0xf bank_mask:0x2
  s_nop 0
  v_add_f32_dpp v76, v49, v76 row_ror:4 row_mask:0xf bank_mask:0x4
  v_add_f32_dpp v77, v51, v77 row_ror:12 row_mask:0xf bank_mask:0x4
  s_nop 0
  v_add_f32_dpp v76, v53, v76 row_ror:8 row_mask:0xf bank_mask:0x8
  v_add_f32_dpp v77, v55, v77 quad_perm:[0,1,2,3] row_mask:0xf bank_mask:0x8
  v_add_f32 v72, v76, v77
  v_cvt_pk_bf16_f32 v72, v72, v72
  v_lshlrev_b32 v72, 16, v72
  v_mul_f32 v72, 0x3db504f3, v72
  v_cvt_pk_bf16_f32 v72, v72, v72
  v_lshlrev_b32 v72, 16, v72
  v_mov_b32 v84, v72
  v_cmp_gt_f32 vcc, v84, v22
  s_cbranch_vccz L_norsh
  v_max_f32_dpp v84, v84, v84 row_ror:4 row_mask:0xf bank_mask:0xf
  s_nop 1
  v_max_f32_dpp v84, v84, v84 row_ror:8 row_mask:0xf bank_mask:0xf
  v_mov_b32 v85, v84
  s_nop 1
  v_permlane16_swap_b32 v84, v85
  v_max_f32 v84, v84, v85
  v_mov_b32 v85, v84
  s_nop 1
  v_permlane32_swap_b32 v84, v85
  v_max_f32 v84, v84, v85
  v_max_f32 v84, v84, v22
  v_sub_f32 v85, v22, v84
  v_mul_f32 v85, 0x3fb8aa3b, v85
  v_exp_f32 v85, v85
  v_mov_b32 v22, v84
  v_mul_f32 v20, 0xbfb8aa3b, v84
  v_mul_f32 v21, v21, v85
  v_mul_f32 v12, v12, v85
  v_mul_f32 v13, v13, v85
  v_mul_f32 v14, v14, v85
  v_mul_f32 v15, v15, v85
  v_mul_f32 v16, v16, v85
  v_mul_f32 v17, v17, v85
  v_mul_f32 v18, v18, v85
  v_mul_f32 v19, v19, v85
L_norsh:
  v_fma_f32 v72, v72, s73, v20
  v_exp_f32 v72, v72
  s_nop 0
  v_add_f32 v21, v21, v72
  v_cvt_pk_bf16_f32 v74, v72, v72
  v_and_b32 v80, 0xffff, v74
  v_lshlrev_b32 v81, 16, v74
  s_nop 0
  v_mov_b32_dpp v24, v80 quad_perm:[0,1,2,3] row_mask:0xf bank_mask:0x1
  v_mov_b32_dpp v25, v80 row_ror:8 row_mask:0xf bank_mask:0x4
  v_mov_b32_dpp v26, v80 row_ror:12 row_mask:0xf bank_mask:0x1
  v_mov_b32_dpp v27, v80 row_ror:4 row_mask:0xf bank_mask:0x4
  v_mov_b32_dpp v24, v81 row_ror:4 row_mask:0xf bank_mask:0x2
  v_mov_b32_dpp v25, v81 row_ror:12 row_mask:0xf bank_mask:0x8
  v_mov_b32_dpp v26, v81 quad_perm:[0,1,2,3] row_mask:0xf bank_mask:0x2
  v_mov_b32_dpp v27, v81 row_ror:8 row_mask:0xf bank_mask:0x8
  v_mov_b32_dpp v28, v80 row_ror:8 row_mask:0xf bank_mask:0x1
  v_mov_b32_dpp v29, v80 quad_perm:[0,1,2,3] row_mask:0xf bank_mask:0x4
  v_mov_b32_dpp v30, v80 row_ror:4 row_mask:0xf bank_mask:0x1
  v_mov_b32_dpp v31, v80 row_ror:12 row_mask:0xf bank_mask:0x4
  v_mov_b32_dpp v28, v81 row_ror:12 row_mask:0xf bank_mask:0x2
  v_mov_b32_dpp v29, v81 row_ror:4 row_mask:0xf bank_mask:0x8
  v_mov_b32_dpp v30, v81 row_ror:8 row_mask:0xf bank_mask:0x2
  v_mov_b32_dpp v31, v81 quad_perm:[0,1,2,3] row_mask:0xf bank_mask:0x8
  s_waitcnt vmcnt(1)
  v_mfma_f32_16x16x16_bf16 v[12:15], v[104:105], v[24:25], v[12:15]
  v_mfma_f32_16x16x16_bf16 v[16:19], v[106:107], v[24:25], v[16:19]
  v_mfma_f32_16x16x16_bf16 v[12:15], v[108:109], v[26:27], v[12:15]
  v_mfma_f32_16x16x16_bf16 v[16:19], v[110:111], v[26:27], v[16:19]
  v_mfma_f32_16x16x16_bf16 v[12:15], v[112:113], v[28:29], v[12:15]
  v_mfma_f32_16x16x16_bf16 v[16:19], v[114:115], v[28:29], v[16:19]
  v_mfma_f32_16x16x16_bf16 v[12:15], v[116:117], v[30:31], v[12:15]
  v_mfma_f32_16x16x16_bf16 v[16:19], v[118:119], v[30:31], v[16:19]
  s_cmp_lg_u32 s67, 1
  s_nop 6
  s_cbranch_scc1 L_hnext
L_done:
  v_lshlrev_b32 v6, 3, v1
  s_lshl_b32 s59, s52, 11
  v_add_u32 v7, s59, v211
  v_lshlrev_b32 v84, 1, v203
  ds_write_b64 v84, v[20:21] offset:12288
  ds_write_b128 v7, v[12:15] offset:4096
  ds_write_b128 v7, v[16:19] offset:5120
  s_mov_b64 exec, 1
  ds_add_rtn_u32 v85, v4, v202 offset:1024
  s_mov_b64 exec, -1
  ds_read_b64 v[24:25], v6 offset:12288
  ds_read_b64 v[26:27], v6 offset:12800
  ds_read_b64 v[28:29], v6 offset:13312
  ds_read_b64 v[30:31], v6 offset:13824
  ds_read_b128 v[40:43], v211 offset:4096
  ds_read_b128 v[44:47], v211 offset:5120
  ds_read_b128 v[48:51], v211 offset:6144
  ds_read_b128 v[52:55], v211 offset:7168
  ds_read_b128 v[56:59], v211 offset:8192
  ds_read_b128 v[60:63], v211 offset:9216
  ds_read_b128 v[64:67], v211 offset:10240
  ds_read_b128 v[68:71], v211 offset:11264
  v_and_b32 v5, 3, v1
  v_lshlrev_b32 v5, 6, v5
  v_lshrrev_b32 v6, 4, v1
  v_lshlrev_b32 v6, 9, v6
  v_and_b32 v7, 12, v1
  v_lshlrev_b32 v7, 2, v7
  v_add3_u32 v6, v5, v6, v7
  v_lshrrev_b32 v5, 2, v5
  v_lshrrev_b32 v7, 2, v1
  v_lshl_add_u32 v5, v7, 7, v5
  s_lshl_b32 s59, s2, 12
  s_add_u32 s59, s59, 65536
  s_waitcnt lgkmcnt(12)
  v_readfirstlane_b32 s71, v85
  s_cmp_lg_u32 s71, 3
  s_cbranch_scc1 L_nopa
  s_waitcnt lgkmcnt(8)
  v_min_f32 v72, v24, v26
  v_min3_f32 v72, v72, v28, v30
  v_sub_f32 v24, v72, v24
  v_sub_f32 v26, v72, v26
  v_sub_f32 v28, v72, v28
  v_sub_f32 v30, v72, v30
  v_exp_f32 v24, v24
  v_exp_f32 v26, v26
  v_exp_f32 v28, v28
  v_exp_f32 v30, v30
  v_mov_b32 v74, s56
  v_mul_f32 v73, v24, v25
  v_fmac_f32 v73, v26, v27
  v_fmac_f32 v73, v28, v29
  v_fmac_f32 v73, v30, v31
  s_waitcnt lgkmcnt(0)
  v_mul_f32 v40, v40, v24
  v_mul_f32 v41, v41, v24
  v_mul_f32 v42, v42, v24
  v_mul_f32 v43, v43, v24
  v_add_f32_dpp v73, v73, v73 row_ror:4 row_mask:0xf bank_mask:0xf
  v_fmac_f32 v40, v48, v26
  v_fmac_f32 v41, v49, v26
  v_fmac_f32 v42, v50, v26
  v_fmac_f32 v43, v51, v26
  v_add_f32_dpp v73, v73, v73 row_ror:8 row_mask:0xf bank_mask:0xf
  v_fmac_f32 v40, v56, v28
  v_fmac_f32 v41, v57, v28
  v_fmac_f32 v42, v58, v28
  v_fmac_f32 v43, v59, v28
  v_mov_b32 v85, v73
  v_fmac_f32 v40, v64, v30
  v_fmac_f32 v41, v65, v30
  v_fmac_f32 v42, v66, v30
  v_fmac_f32 v43, v67, v30
  v_permlane16_swap_b32 v73, v85
  v_and_or_b32 v40, v40, s70, v205
  v_and_or_b32 v41, v41, s70, v206
  v_and_or_b32 v42, v42, s70, v207
  v_and_or_b32 v43, v43, s70, v208
  v_add_f32 v73, v73, v85
  v_mov_b32 v85, v73
  buffer_store_dwordx4 v[40:43], v6, s[36:39], s59 offen offset:0 sc1
  v_mul_f32 v44, v44, v24
  v_mul_f32 v45, v45, v24
  v_mul_f32 v46, v46, v24
  v_mul_f32 v47, v47, v24
  v_fmac_f32 v44, v52, v26
  v_fmac_f32 v45, v53, v26
  v_fmac_f32 v46, v54, v26
  v_fmac_f32 v47, v55, v26
  v_permlane32_swap_b32 v73, v85
  v_fmac_f32 v44, v60, v28
  v_fmac_f32 v45, v61, v28
  v_fmac_f32 v46, v62, v28
  v_fmac_f32 v47, v63, v28
  v_fmac_f32 v44, v68, v30
  v_fmac_f32 v45, v69, v30
  v_fmac_f32 v46, v70, v30
  v_fmac_f32 v47, v71, v30
  v_and_or_b32 v44, v44, s70, v205
  v_and_or_b32 v45, v45, s70, v206
  v_and_or_b32 v46, v46, s70, v207
  v_and_or_b32 v47, v47, s70, v208
  v_add_f32 v73, v73, v85
  buffer_store_dwordx4 v[44:47], v6, s[36:39], s59 offen offset:256 sc1
  s_mov_b32 exec_hi, 0
  buffer_store_dwordx3 v[72:74], v5, s[36:39], s59 offen offset:2048 sc1
  s_mov_b64 exec, -1
L_nopa:
  s_waitcnt lgkmcnt(0)
  v_mov_b32 v56, 0
  v_mov_b32 v57, 0
  v_mov_b32 v58, 0
  v_mov_b32 v59, 0
  v_mov_b32 v60, 0
  v_mov_b32 v61, 0
  v_mov_b32 v62, 0
  v_mov_b32 v63, 0
  v_mov_b32 v64, 0
  v_mov_b32 v65, 0
  v_mov_b32 v66, 0
  v_mov_b32 v67, 0
  v_mov_b32 v68, 0
  v_mov_b32 v69, 0
  v_mov_b32 v70, 0
  v_mov_b32 v71, 0
  v_mov_b32 v32, 0
  v_mov_b32 v33, 0
  v_mov_b32 v34, 0
  v_mov_b32 v35, 0
  v_mov_b32 v36, 0
  v_mov_b32 v37, 0
  v_mov_b32 v38, 0
  v_mov_b32 v39, 0
  s_cmp_eq_u32 s55, 1
  s_cbranch_scc1 L_roleC
  s_and_b32 s59, s55, 1
  s_lshl_b32 s59, s59, 1
  s_or_b32 s59, s59, s71
  s_cmp_ge_u32 s59, 2
  s_cbranch_scc1 L_finb
  s_and_b32 s77, s2, 0xf7
  s_lshl_b32 s59, s71, 3
  s_or_b32 s77, s77, s59
  s_lshr_b32 s72, s77, 1
  s_lshl_b32 s72, s72, 15
  s_and_b32 s59, s2, 1
  s_lshl_b32 s59, s59, 12
  s_add_u32 s72, s72, s59
  s_mov_b32 s40, s12
  s_mov_b32 s41, s13
  s_mov_b32 s42, 0x400000
  s_mov_b32 s43, 0x20000
  buffer_load_dwordx4 v[88:91], v211, s[40:43], s72 offen offset:0 nt
  buffer_load_dwordx4 v[92:95], v211, s[40:43], s72 offen offset:1024 nt
  buffer_load_dwordx4 v[96:99], v211, s[40:43], s72 offen offset:2048 nt
  buffer_load_dwordx4 v[100:103], v211, s[40:43], s72 offen offset:3072 nt
  s_add_u32 s72, s72, 8192
  buffer_load_dwordx4 v[104:107], v211, s[40:43], s72 offen offset:0 nt
  buffer_load_dwordx4 v[108:111], v211, s[40:43], s72 offen offset:1024 nt
  buffer_load_dwordx4 v[112:115], v211, s[40:43], s72 offen offset:2048 nt
  buffer_load_dwordx4 v[116:119], v211, s[40:43], s72 offen offset:3072 nt
  s_barrier
  s_add_u32 s72, s72, 8192
  buffer_load_dwordx4 v[120:123], v211, s[40:43], s72 offen offset:0 nt
  buffer_load_dwordx4 v[124:127], v211, s[40:43], s72 offen offset:1024 nt
  buffer_load_dwordx4 v[128:131], v211, s[40:43], s72 offen offset:2048 nt
  buffer_load_dwordx4 v[132:135], v211, s[40:43], s72 offen offset:3072 nt
  s_add_u32 s72, s72, 8192
  buffer_load_dwordx4 v[136:139], v211, s[40:43], s72 offen offset:0 nt
  buffer_load_dwordx4 v[140:143], v211, s[40:43], s72 offen offset:1024 nt
  buffer_load_dwordx4 v[144:147], v211, s[40:43], s72 offen offset:2048 nt
  buffer_load_dwordx4 v[148:151], v211, s[40:43], s72 offen offset:3072 nt
L_tail:
  v_lshrrev_b32 v5, 2, v1
  v_lshlrev_b32 v5, 12, v5
  v_and_b32 v6, 3, v1
  v_lshlrev_b32 v6, 4, v6
  s_lshl_b32 s59, s60, 5
  s_and_b32 s65, s77, 24
  s_add_u32 s59, s59, s65
  s_lshl_b32 s59, s59, 3
  v_add3_u32 v6, v6, v5, s59
  s_lshl_b32 s59, s60, 6
  s_add_u32 s59, s59, s65
  s_lshl_b32 s59, s59, 1
  v_add_u32 v5, s59, v5
  s_lshl_b32 s59, s53, 17
  s_add_u32 s59, s59, 65536
  s_add_u32 s65, s59, 0x10000
  s_lshl_b32 s72, s77, 11
  s_add_u32 s72, s72, 1114112
  buffer_load_dwordx3 v[48:50], v5, s[36:39], s59 offen offset:2048 sc1
  buffer_load_dwordx3 v[52:54], v5, s[36:39], s65 offen offset:2048 sc1
  buffer_load_dwordx4 v[40:43], v6, s[36:39], s59 offen sc1
  buffer_load_dwordx4 v[44:47], v6, s[36:39], s65 offen sc1
  s_mov_b32 s64, 200000
  s_waitcnt vmcnt(4)
  v_perm_b32 v200, v92, v88, s62
  v_perm_b32 v92, v92, v88, s63
  v_perm_b32 v88, v93, v89, s62
  v_perm_b32 v93, v93, v89, s63
  v_perm_b32 v89, v94, v90, s62
  v_perm_b32 v94, v94, v90, s63
  v_perm_b32 v90, v95, v91, s62
  v_perm_b32 v95, v95, v91, s63
  v_perm_b32 v91, v100, v96, s62
  v_perm_b32 v100, v100, v96, s63
  v_perm_b32 v96, v101, v97, s62
  v_perm_b32 v101, v101, v97, s63
  v_perm_b32 v97, v102, v98, s62
  v_perm_b32 v102, v102, v98, s63
  v_perm_b32 v98, v103, v99, s62
  v_perm_b32 v103, v103, v99, s63
  v_perm_b32 v99, v108, v104, s62
  v_perm_b32 v108, v108, v104, s63
  v_perm_b32 v104, v109, v105, s62
  v_perm_b32 v109, v109, v105, s63
  v_perm_b32 v105, v110, v106, s62
  v_perm_b32 v110, v110, v106, s63
  v_perm_b32 v106, v111, v107, s62
  v_perm_b32 v111, v111, v107, s63
  v_perm_b32 v107, v116, v112, s62
  v_perm_b32 v116, v116, v112, s63
  v_perm_b32 v112, v117, v113, s62
  v_perm_b32 v117, v117, v113, s63
  v_perm_b32 v113, v118, v114, s62
  v_perm_b32 v118, v118, v114, s63
  v_perm_b32 v114, v119, v115, s62
  v_perm_b32 v119, v119, v115, s63
  v_perm_b32 v115, v124, v120, s62
  v_perm_b32 v124, v124, v120, s63
  v_perm_b32 v120, v125, v121, s62
  v_perm_b32 v125, v125, v121, s63
  v_perm_b32 v121, v126, v122, s62
  v_perm_b32 v126, v126, v122, s63
  v_perm_b32 v122, v127, v123, s62
  v_perm_b32 v127, v127, v123, s63
  v_perm_b32 v123, v132, v128, s62
  v_perm_b32 v132, v132, v128, s63
  v_perm_b32 v128, v133, v129, s62
  v_perm_b32 v133, v133, v129, s63
  v_perm_b32 v129, v134, v130, s62
  v_perm_b32 v134, v134, v130, s63
  v_perm_b32 v130, v135, v131, s62
  v_perm_b32 v135, v135, v131, s63
  v_perm_b32 v131, v140, v136, s62
  v_perm_b32 v140, v140, v136, s63
  v_perm_b32 v136, v141, v137, s62
  v_perm_b32 v141, v141, v137, s63
  v_perm_b32 v137, v142, v138, s62
  v_perm_b32 v142, v142, v138, s63
  v_perm_b32 v138, v143, v139, s62
  v_perm_b32 v143, v143, v139, s63
  v_perm_b32 v139, v148, v144, s62
  v_perm_b32 v148, v148, v144, s63
  v_perm_b32 v144, v149, v145, s62
  v_perm_b32 v149, v149, v145, s63
  v_perm_b32 v145, v150, v146, s62
  v_perm_b32 v150, v150, v146, s63
  v_perm_b32 v146, v151, v147, s62
  v_perm_b32 v151, v151, v147, s63
  s_branch L_hA_chk
  s_mov_b32 s64, 200000
L_hA:
  buffer_load_dwordx3 v[48:50], v5, s[36:39], s59 offen offset:2048 sc1
  buffer_load_dwordx3 v[52:54], v5, s[36:39], s65 offen offset:2048 sc1
  buffer_load_dwordx4 v[40:43], v6, s[36:39], s59 offen sc1
  buffer_load_dwordx4 v[44:47], v6, s[36:39], s65 offen sc1
L_hA_chk:
  s_waitcnt vmcnt(2)
  v_xor_b32 v84, s56, v50
  v_bitop3_b32 v84, v84, v54, s56 bitop3:0xf6
  v_min_f32 v72, v48, v52
  s_waitcnt vmcnt(1)
  v_xor_b32 v85, v40, v205
  v_bitop3_b32 v85, v85, v41, v206 bitop3:0xf6
  v_bitop3_b32 v85, v85, v42, v207 bitop3:0xf6
  v_bitop3_b32 v85, v85, v43, v208 bitop3:0xf6
  s_waitcnt vmcnt(0)
  v_bitop3_b32 v85, v85, v44, v205 bitop3:0xf6
  v_bitop3_b32 v85, v85, v45, v206 bitop3:0xf6
  v_bitop3_b32 v85, v85, v46, v207 bitop3:0xf6
  v_bitop3_b32 v85, v85, v47, v208 bitop3:0xf6
  v_lshl_or_b32 v84, v85, 24, v84
  v_cmp_ne_u32 vcc, 0, v84
  s_cbranch_vccz L_hA_ok
  s_mov_b64 exec, vcc
  s_sub_u32 s64, s64, 1
  s_cmp_lg_u32 s64, 0
  s_cbranch_scc1 L_hA
L_hA_ok:
  s_mov_b64 exec, -1
  v_min_f32_dpp v72, v72, v72 row_ror:4 row_mask:0xf bank_mask:0xf
  s_nop 1
  v_min_f32_dpp v72, v72, v72 row_ror:8 row_mask:0xf bank_mask:0xf
  v_mov_b32 v85, v72
  s_nop 1
  v_permlane16_swap_b32 v72, v85
  v_min_f32 v72, v72, v85
  v_mov_b32 v85, v72
  s_nop 1
  v_permlane32_swap_b32 v72, v85
  v_min_f32 v72, v72, v85
  v_sub_f32 v48, v72, v48
  v_sub_f32 v52, v72, v52
  v_exp_f32 v48, v48
  v_exp_f32 v52, v52
  v_mul_f32 v73, v48, v49
  v_fmac_f32 v73, v52, v53
  v_mul_f32 v40, v40, v48
  v_mul_f32 v41, v41, v48
  v_mul_f32 v42, v42, v48
  v_mul_f32 v43, v43, v48
  v_add_f32_dpp v73, v73, v73 row_ror:4 row_mask:0xf bank_mask:0xf
  v_fmac_f32 v40, v44, v52
  v_fmac_f32 v41, v45, v52
  v_fmac_f32 v42, v46, v52
  v_fmac_f32 v43, v47, v52
  v_add_f32_dpp v73, v73, v73 row_ror:8 row_mask:0xf bank_mask:0xf
  v_mov_b32 v85, v73
  v_permlane32_swap_b32 v40, v42
  v_permlane32_swap_b32 v41, v43
  v_permlane32_swap_b32 v73, v85
  v_add_f32 v40, v40, v42
  v_add_f32 v41, v41, v43
  v_add_f32 v73, v73, v85
  v_mov_b32 v85, v73
  v_permlane16_swap_b32 v40, v41
  s_nop 0
  v_permlane16_swap_b32 v73, v85
  v_add_f32 v40, v40, v41
  v_add_f32 v73, v73, v85
  v_rcp_f32 v73, v73
  v_add_f32_dpp v40, v40, v40 row_ror:4 row_mask:0xf bank_mask:0xf
  s_nop 1
  v_add_f32_dpp v40, v40, v40 row_ror:8 row_mask:0xf bank_mask:0xf
  v_mul_f32 v40, v40, v73
  s_nop 1
  v_mov_b32_dpp v85, v40 quad_perm:[1,1,3,3] row_mask:0xf bank_mask:0xf
  v_cvt_pk_bf16_f32 v76, v40, v85
  s_nop 0
  v_readlane_b32 s40, v76, 0
  v_readlane_b32 s41, v76, 2
  v_readlane_b32 s42, v76, 16
  v_readlane_b32 s43, v76, 18
  v_readlane_b32 s44, v76, 32
  v_readlane_b32 s45, v76, 34
  v_readlane_b32 s46, v76, 48
  v_readlane_b32 s47, v76, 50
  v_dot2c_f32_bf16 v32, s40, v200
  v_dot2c_f32_bf16 v33, s40, v92
  v_dot2c_f32_bf16 v34, s40, v88
  v_dot2c_f32_bf16 v35, s40, v93
  v_dot2c_f32_bf16 v32, s41, v91
  v_dot2c_f32_bf16 v33, s41, v100
  v_dot2c_f32_bf16 v34, s41, v96
  v_dot2c_f32_bf16 v35, s41, v101
  v_dot2c_f32_bf16 v32, s42, v99
  v_dot2c_f32_bf16 v33, s42, v108
  v_dot2c_f32_bf16 v34, s42, v104
  v_dot2c_f32_bf16 v35, s42, v109
  v_dot2c_f32_bf16 v32, s43, v107
  v_dot2c_f32_bf16 v33, s43, v116
  v_dot2c_f32_bf16 v34, s43, v112
  v_dot2c_f32_bf16 v35, s43, v117
  v_dot2c_f32_bf16 v32, s44, v115
  v_dot2c_f32_bf16 v33, s44, v124
  v_dot2c_f32_bf16 v34, s44, v120
  v_dot2c_f32_bf16 v35, s44, v125
  v_dot2c_f32_bf16 v32, s45, v123
  v_dot2c_f32_bf16 v33, s45, v132
  v_dot2c_f32_bf16 v34, s45, v128
  v_dot2c_f32_bf16 v35, s45, v133
  v_dot2c_f32_bf16 v32, s46, v131
  v_dot2c_f32_bf16 v33, s46, v140
  v_dot2c_f32_bf16 v34, s46, v136
  v_dot2c_f32_bf16 v35, s46, v141
  v_dot2c_f32_bf16 v32, s47, v139
  v_dot2c_f32_bf16 v33, s47, v148
  v_dot2c_f32_bf16 v34, s47, v144
  v_dot2c_f32_bf16 v35, s47, v149
  v_dot2c_f32_bf16 v36, s40, v89
  v_dot2c_f32_bf16 v37, s40, v94
  v_dot2c_f32_bf16 v38, s40, v90
  v_dot2c_f32_bf16 v39, s40, v95
  v_and_or_b32 v32, v32, s70, v205
  v_and_or_b32 v33, v33, s70, v206
  v_and_or_b32 v34, v34, s70, v207
  v_and_or_b32 v35, v35, s70, v208
  buffer_store_dwordx4 v[32:35], v211, s[36:39], s72 offen sc1
  v_dot2c_f32_bf16 v36, s41, v97
  v_dot2c_f32_bf16 v37, s41, v102
  v_dot2c_f32_bf16 v38, s41, v98
  v_dot2c_f32_bf16 v39, s41, v103
  v_dot2c_f32_bf16 v36, s42, v105
  v_dot2c_f32_bf16 v37, s42, v110
  v_dot2c_f32_bf16 v38, s42, v106
  v_dot2c_f32_bf16 v39, s42, v111
  v_dot2c_f32_bf16 v36, s43, v113
  v_dot2c_f32_bf16 v37, s43, v118
  v_dot2c_f32_bf16 v38, s43, v114
  v_dot2c_f32_bf16 v39, s43, v119
  v_dot2c_f32_bf16 v36, s44, v121
  v_dot2c_f32_bf16 v37, s44, v126
  v_dot2c_f32_bf16 v38, s44, v122
  v_dot2c_f32_bf16 v39, s44, v127
  v_dot2c_f32_bf16 v36, s45, v129
  v_dot2c_f32_bf16 v37, s45, v134
  v_dot2c_f32_bf16 v38, s45, v130
  v_dot2c_f32_bf16 v39, s45, v135
  v_dot2c_f32_bf16 v36, s46, v137
  v_dot2c_f32_bf16 v37, s46, v142
  v_dot2c_f32_bf16 v38, s46, v138
  v_dot2c_f32_bf16 v39, s46, v143
  v_dot2c_f32_bf16 v36, s47, v145
  v_dot2c_f32_bf16 v37, s47, v150
  v_dot2c_f32_bf16 v38, s47, v146
  v_dot2c_f32_bf16 v39, s47, v151
  v_and_or_b32 v36, v36, s70, v205
  v_and_or_b32 v37, v37, s70, v206
  v_and_or_b32 v38, v38, s70, v207
  v_and_or_b32 v39, v39, s70, v208
  buffer_store_dwordx4 v[36:39], v211, s[36:39], s72 offen offset:1024 sc1
  s_cmp_lg_u32 s71, 0
  s_cbranch_scc1 L_fin
  v_mov_b32 v77, s56
  v_and_b32 v80, 1, v1
  v_lshrrev_b32 v81, 5, v1
  v_lshrrev_b32 v82, 1, v1
  v_and_b32 v79, 4, v1
  v_lshlrev_b32 v79, 2, v79
  v_sub_u32 v79, 16, v79
  v_lshlrev_b32 v83, 4, v80
  s_cmp_eq_u32 s55, 2
  s_cbranch_scc1 L_roleD
  s_and_b32 s59, s66, 31
  s_lshl_b32 s59, s59, 5
  s_lshr_b32 s65, s66, 5
  s_lshl_b32 s72, s65, 3
  s_add_u32 s72, s72, s59
  v_lshl_add_u32 v5, v81, 2, v83
  v_add_u32 v5, s72, v5
  global_load_dword v24, v5, s[4:5]
  s_lshl_b32 s65, s65, 10
  s_add_u32 s59, s59, s65
  s_add_u32 s40, s59, 1114112
  s_add_u32 s41, s59, 1118208
  s_add_u32 s42, s59, 1122304
  s_add_u32 s43, s59, 1126400
  v_lshl_add_u32 v5, v82, 14, v83
  v_lshl_add_u32 v6, v81, 3, v83
  s_lshl_b32 s65, s66, 6
  s_add_u32 s65, s65, 32768
  v_bfe_u32 v7, v1, 3, 2
  v_and_b32 v78, 2, v1
  v_lshl_add_u32 v7, v78, 1, v7
  v_lshl_add_u32 v7, v7, 13, v6
  s_mul_i32 s72, s66, 128
  s_add_u32 s72, s72, 1966080
  s_sleep 20
  s_mov_b32 s64, 200000
L_hB:
  buffer_load_dwordx4 v[40:43], v5, s[36:39], s40 offen offset:0 sc1
  buffer_load_dwordx4 v[44:47], v5, s[36:39], s40 offen offset:2048 sc1
  buffer_load_dwordx4 v[48:51], v5, s[36:39], s41 offen offset:0 sc1
  buffer_load_dwordx4 v[52:55], v5, s[36:39], s41 offen offset:2048 sc1
  buffer_load_dwordx4 v[56:59], v5, s[36:39], s42 offen offset:0 sc1
  buffer_load_dwordx4 v[60:63], v5, s[36:39], s42 offen offset:2048 sc1
  buffer_load_dwordx4 v[64:67], v5, s[36:39], s43 offen offset:0 sc1
  buffer_load_dwordx4 v[68:71], v5, s[36:39], s43 offen offset:2048 sc1
  s_waitcnt vmcnt(7)
  v_xor_b32 v84, v40, v205
  v_bitop3_b32 v84, v84, v41, v206 bitop3:0xf6
  v_bitop3_b32 v84, v84, v42, v207 bitop3:0xf6
  v_bitop3_b32 v84, v84, v43, v208 bitop3:0xf6
  s_waitcnt vmcnt(6)
  v_bitop3_b32 v84, v84, v44, v205 bitop3:0xf6
  v_bitop3_b32 v84, v84, v45, v206 bitop3:0xf6
  v_bitop3_b32 v84, v84, v46, v207 bitop3:0xf6
  v_bitop3_b32 v84, v84, v47, v208 bitop3:0xf6
  v_pk_add_f32 v[28:29], v[40:41], v[44:45]
  v_pk_add_f32 v[30:31], v[42:43], v[46:47]
  s_waitcnt vmcnt(5)
  v_bitop3_b32 v84, v84, v48, v205 bitop3:0xf6
  v_bitop3_b32 v84, v84, v49, v206 bitop3:0xf6
  v_bitop3_b32 v84, v84, v50, v207 bitop3:0xf6
  v_bitop3_b32 v84, v84, v51, v208 bitop3:0xf6
  v_pk_add_f32 v[28:29], v[28:29], v[48:49]
  v_pk_add_f32 v[30:31], v[30:31], v[50:51]
  s_waitcnt vmcnt(4)
  v_bitop3_b32 v84, v84, v52, v205 bitop3:0xf6
  v_bitop3_b32 v84, v84, v53, v206 bitop3:0xf6
  v_bitop3_b32 v84, v84, v54, v207 bitop3:0xf6
  v_bitop3_b32 v84, v84, v55, v208 bitop3:0xf6
  v_pk_add_f32 v[28:29], v[28:29], v[52:53]
  v_pk_add_f32 v[30:31], v[30:31], v[54:55]
  s_waitcnt vmcnt(3)
  v_bitop3_b32 v84, v84, v56, v205 bitop3:0xf6
  v_bitop3_b32 v84, v84, v57, v206 bitop3:0xf6
  v_bitop3_b32 v84, v84, v58, v207 bitop3:0xf6
  v_bitop3_b32 v84, v84, v59, v208 bitop3:0xf6
  v_pk_add_f32 v[28:29], v[28:29], v[56:57]
  v_pk_add_f32 v[30:31], v[30:31], v[58:59]
  s_waitcnt vmcnt(2)
  v_bitop3_b32 v84, v84, v60, v205 bitop3:0xf6
  v_bitop3_b32 v84, v84, v61, v206 bitop3:0xf6
  v_bitop3_b32 v84, v84, v62, v207 bitop3:0xf6
  v_bitop3_b32 v84, v84, v63, v208 bitop3:0xf6
  v_pk_add_f32 v[28:29], v[28:29], v[60:61]
  v_pk_add_f32 v[30:31], v[30:31], v[62:63]
  s_waitcnt vmcnt(1)
  v_bitop3_b32 v84, v84, v64, v205 bitop3:0xf6
  v_bitop3_b32 v84, v84, v65, v206 bitop3:0xf6
  v_bitop3_b32 v84, v84, v66, v207 bitop3:0xf6
  v_bitop3_b32 v84, v84, v67, v208 bitop3:0xf6
  v_pk_add_f32 v[28:29], v[28:29], v[64:65]
  v_pk_add_f32 v[30:31], v[30:31], v[66:67]
  s_waitcnt vmcnt(0)
  v_bitop3_b32 v84, v84, v68, v205 bitop3:0xf6
  v_bitop3_b32 v84, v84, v69, v206 bitop3:0xf6
  v_bitop3_b32 v84, v84, v70, v207 bitop3:0xf6
  v_bitop3_b32 v84, v84, v71, v208 bitop3:0xf6
  v_pk_add_f32 v[28:29], v[28:29], v[68:69]
  v_pk_add_f32 v[30:31], v[30:31], v[70:71]
  v_cmp_ne_u32_sdwa vcc, v84, v4 src0_sel:BYTE_0 src1_sel:DWORD
  s_cbranch_vccz L_hB_ok
  s_mov_b64 exec, vcc
  s_sub_u32 s64, s64, 1
  s_cmp_lg_u32 s64, 0
  s_cbranch_scc1 L_hB
L_hB_ok:
  s_mov_b64 exec, -1
  v_lshlrev_b32 v24, v79, v24
  v_and_b32 v24, 0xffff0000, v24
  v_permlane32_swap_b32 v28, v30
  v_permlane32_swap_b32 v29, v31
  v_add_f32 v28, v28, v30
  v_add_f32 v29, v29, v31
  s_nop 0
  v_add_f32_dpp v28, v28, v28 row_ror:12 row_mask:0xf bank_mask:0x5
  s_nop 1
  v_add_f32_dpp v28, v29, v29 row_ror:4 row_mask:0xf bank_mask:0xa
  s_nop 1
  v_add_f32_dpp v28, v28, v28 row_ror:8 row_mask:0xf bank_mask:0xf
  s_nop 1
  v_add_f32_dpp v28, v28, v28 quad_perm:[2,3,0,1] row_mask:0xf bank_mask:0xf
  v_mov_b32 v29, v28
  s_nop 1
  v_permlane16_swap_b32 v28, v29
  v_add_f32 v28, v28, v29
  v_cvt_pk_bf16_f32 v72, v28, v28
  v_lshlrev_b32 v72, 16, v72
  v_add_f32 v72, v72, v24
  s_nop 1
  v_mov_b32_dpp v73, v72 row_ror:12 row_mask:0xf bank_mask:0xf
  v_cvt_pk_bf16_f32 v76, v72, v73
  s_mov_b32 exec_lo, 3
  s_mov_b32 exec_hi, 3
  s_mov_b32 exec_lo, 0x0f0f0f0f
  s_mov_b32 exec_hi, 0x0f0f0f0f
  buffer_store_dwordx2 v[76:77], v7, s[36:39], s72 offen sc1
  s_mov_b32 exec_lo, 3
  s_mov_b32 exec_hi, 3
  buffer_store_dwordx2 v[76:77], v6, s[36:39], s65 offen sc1
  s_branch L_fin
L_roleD:
  v_lshlrev_b32 v5, 11, v80
  v_lshl_add_u32 v5, v81, 3, v5
  s_lshr_b32 s59, s66, 1
  s_lshl_b32 s59, s59, 6
  s_and_b32 s65, s66, 1
  s_lshl_b32 s65, s65, 4
  s_add_u32 s59, s59, s65
  s_add_u32 s59, s59, 32768
  v_mov_b32 v28, 0
  v_mov_b32 v29, 0
  v_mov_b32 v30, 0
  v_mov_b32 v31, 0
  s_mov_b32 s64, 200000
L_hD1:
  buffer_load_dwordx2 v[24:25], v5, s[36:39], s59 offen sc1
  s_waitcnt vmcnt(0)
  v_cmp_ne_u32 vcc, s56, v25
  s_cbranch_vccz L_hD1_ok
  s_mov_b64 exec, vcc
  s_sleep 4
  s_sub_u32 s64, s64, 1
  s_cmp_lg_u32 s64, 0
  s_cbranch_scc1 L_hD1
L_hD1_ok:
  s_mov_b64 exec, -1
  v_lshlrev_b32 v24, v79, v24
  v_and_b32 v24, 0xffff0000, v24
  s_lshl_b32 s59, s66, 4
  v_lshlrev_b32 v6, 3, v80
  v_lshl_add_u32 v6, v81, 2, v6
  v_add_u32 v6, s59, v6
  s_lshl_b32 s59, s66, 5
  s_add_u32 s40, s59, 1638400
  s_add_u32 s41, s59, 1642496
  v_lshl_add_u32 v5, v82, 13, v83
  s_sleep 42
  s_mov_b32 exec_hi, 0x00ffffff
  s_mov_b32 s64, 200000
L_hD:
  buffer_load_dwordx4 v[40:43], v5, s[36:39], s40 offen offset:0 sc1
  buffer_load_dwordx4 v[44:47], v5, s[36:39], s40 offen offset:2048 sc1
  buffer_load_dwordx4 v[48:51], v5, s[36:39], s41 offen offset:0 sc1
  buffer_load_dwordx4 v[52:55], v5, s[36:39], s41 offen offset:2048 sc1
  s_waitcnt vmcnt(3)
  v_xor_b32 v84, v40, v205
  v_bitop3_b32 v84, v84, v41, v206 bitop3:0xf6
  v_bitop3_b32 v84, v84, v42, v207 bitop3:0xf6
  v_bitop3_b32 v84, v84, v43, v208 bitop3:0xf6
  s_waitcnt vmcnt(2)
  v_bitop3_b32 v84, v84, v44, v205 bitop3:0xf6
  v_bitop3_b32 v84, v84, v45, v206 bitop3:0xf6
  v_bitop3_b32 v84, v84, v46, v207 bitop3:0xf6
  v_bitop3_b32 v84, v84, v47, v208 bitop3:0xf6
  v_pk_add_f32 v[28:29], v[40:41], v[44:45]
  v_pk_add_f32 v[30:31], v[42:43], v[46:47]
  s_waitcnt vmcnt(1)
  v_bitop3_b32 v84, v84, v48, v205 bitop3:0xf6
  v_bitop3_b32 v84, v84, v49, v206 bitop3:0xf6
  v_bitop3_b32 v84, v84, v50, v207 bitop3:0xf6
  v_bitop3_b32 v84, v84, v51, v208 bitop3:0xf6
  v_pk_add_f32 v[28:29], v[28:29], v[48:49]
  v_pk_add_f32 v[30:31], v[30:31], v[50:51]
  s_waitcnt vmcnt(0)
  v_bitop3_b32 v84, v84, v52, v205 bitop3:0xf6
  v_bitop3_b32 v84, v84, v53, v206 bitop3:0xf6
  v_bitop3_b32 v84, v84, v54, v207 bitop3:0xf6
  v_bitop3_b32 v84, v84, v55, v208 bitop3:0xf6
  v_pk_add_f32 v[28:29], v[28:29], v[52:53]
  v_pk_add_f32 v[30:31], v[30:31], v[54:55]
  v_cmp_ne_u32_sdwa vcc, v84, v4 src0_sel:BYTE_0 src1_sel:DWORD
  s_cbranch_vccz L_hD_ok
  s_mov_b64 exec, vcc
  s_sub_u32 s64, s64, 1
  s_cmp_lg_u32 s64, 0
  s_cbranch_scc1 L_hD
L_hD_ok:
  s_mov_b64 exec, -1
  v_permlane32_swap_b32 v28, v30
  v_permlane32_swap_b32 v29, v31
  v_add_f32 v28, v28, v30
  v_add_f32 v29, v29, v31
  s_nop 0
  v_add_f32_dpp v28, v28, v28 row_ror:12 row_mask:0xf bank_mask:0x5
  s_nop 1
  v_add_f32_dpp v28, v29, v29 row_ror:4 row_mask:0xf bank_mask:0xa
  s_nop 1
  v_add_f32_dpp v28, v28, v28 row_ror:8 row_mask:0xf bank_mask:0xf
  s_nop 1
  v_add_f32_dpp v28, v28, v28 quad_perm:[2,3,0,1] row_mask:0xf bank_mask:0xf
  v_mov_b32 v29, v28
  s_nop 1
  v_permlane16_swap_b32 v28, v29
  v_add_f32 v28, v28, v29
  v_cvt_pk_bf16_f32 v72, v28, v28
  v_lshlrev_b32 v72, 16, v72
  v_add_f32 v72, v72, v24
  s_nop 1
  v_mov_b32_dpp v73, v72 row_ror:12 row_mask:0xf bank_mask:0xf
  v_cvt_pk_bf16_f32 v76, v72, v73
  s_mov_b32 exec_lo, 3
  s_mov_b32 exec_hi, 3
  global_store_dword v6, v76, s[22:23]
  s_cmp_lg_u32 s66, 0
  s_cbranch_scc1 L_fin
  s_mov_b64 exec, 1
  buffer_store_dword v77, v4, s[36:39], 0 offen offset:0 sc0 sc1
  s_branch L_fin
L_roleC:
  s_mov_b32 s28, s20
  s_mov_b32 s29, s21
  s_mov_b32 s30, 0x1c0000
  s_mov_b32 s31, 0x20000
  v_lshlrev_b32 v248, 1, v203
  s_lshl_b32 s65, s66, 11
  s_add_u32 s65, s65, 1638400
  buffer_load_dwordx2 v[244:245], v248, s[36:39], s65 offen sc1
  v_lshrrev_b32 v7, 1, v1
  v_lshlrev_b32 v7, 7, v7
  v_and_b32 v72, 1, v1
  v_lshl_add_u32 v7, v72, 4, v7
  s_lshl_b32 s72, s60, 13
  s_add_u32 s72, s72, 1966080
  s_add_u32 s68, s72, 4096
  v_lshrrev_b32 v5, 1, v0
  v_mul_u32_u24 v5, 14336, v5
  v_and_b32 v6, 16, v211
  s_lshl_b32 s59, s66, 5
  v_add3_u32 v5, v5, v6, s59
  s_mov_b32 s40, s16
  s_mov_b32 s41, s17
  s_mov_b32 s42, 0x1c0000
  s_mov_b32 s43, 0x20000
  s_mov_b32 s44, s18
  s_mov_b32 s45, s19
  s_mov_b32 s46, 0x1c0000
  s_mov_b32 s47, 0x20000
  s_mul_i32 s59, s60, 14
  s_sub_u32 s65, s66, s59
  s_lshl_b32 s65, s65, 8
  s_lshl_b32 s59, s59, 5
  v_add_u32 v72, s65, v0
  v_mul_u32_u24 v76, 9363, v72
  v_lshrrev_b32 v76, 16, v76
  v_mul_u32_u24 v76, 49, v76
  v_add_lshl_u32 v72, v72, v76, 6
  buffer_load_dword v76, v72, s[40:43], s59 offen
  buffer_load_dword v77, v72, s[44:47], s59 offen
  s_barrier
  buffer_load_dwordx4 v[152:155], v5, s[40:43], 0 offen nt
  buffer_load_dwordx4 v[168:171], v5, s[44:47], 0 offen nt
  s_mov_b32 s59, 3584
  buffer_load_dwordx4 v[156:159], v5, s[40:43], s59 offen nt
  buffer_load_dwordx4 v[172:175], v5, s[44:47], s59 offen nt
  s_mov_b32 s59, 7168
  buffer_load_dwordx4 v[160:163], v5, s[40:43], s59 offen nt
  buffer_load_dwordx4 v[176:179], v5, s[44:47], s59 offen nt
  s_mov_b32 s59, 10752
  buffer_load_dwordx4 v[164:167], v5, s[40:43], s59 offen nt
  buffer_load_dwordx4 v[180:183], v5, s[44:47], s59 offen nt
  s_cmp_eq_u32 s74, 0
  s_cbranch_scc1 L_Cnt
  s_lshl_b32 s59, s66, 14
  buffer_load_dword v184, v203, s[28:31], s59 offen offset:0 nt
  buffer_load_dword v185, v203, s[28:31], s59 offen offset:1024 nt
  buffer_load_dword v186, v203, s[28:31], s59 offen offset:2048 nt
  buffer_load_dword v187, v203, s[28:31], s59 offen offset:3072 nt
  s_add_u32 s59, s59, 4096
  buffer_load_dword v188, v203, s[28:31], s59 offen offset:0 nt
  buffer_load_dword v189, v203, s[28:31], s59 offen offset:1024 nt
  buffer_load_dword v190, v203, s[28:31], s59 offen offset:2048 nt
  buffer_load_dword v191, v203, s[28:31], s59 offen offset:3072 nt
  buffer_load_dwordx4 v[40:43], v7, s[36:39], s72 offen sc1
  buffer_load_dwordx4 v[44:47], v7, s[36:39], s68 offen sc1
  s_add_u32 s59, s59, 4096
  buffer_load_dword v192, v203, s[28:31], s59 offen offset:0 nt
  buffer_load_dword v193, v203, s[28:31], s59 offen offset:1024 nt
  buffer_load_dword v194, v203, s[28:31], s59 offen offset:2048 nt
  buffer_load_dword v195, v203, s[28:31], s59 offen offset:3072 nt
  s_add_u32 s59, s59, 4096
  buffer_load_dword v196, v203, s[28:31], s59 offen offset:0 nt
  buffer_load_dword v197, v203, s[28:31], s59 offen offset:1024 nt
  buffer_load_dword v198, v203, s[28:31], s59 offen offset:2048 nt
  buffer_load_dword v199, v203, s[28:31], s59 offen offset:3072 nt
  s_mov_b32 s64, 200000
  s_waitcnt vmcnt(22)
  v_perm_b32 v200, v156, v152, s62
  v_perm_b32 v156, v156, v152, s63
  v_perm_b32 v152, v157, v153, s62
  v_perm_b32 v157, v157, v153, s63
  v_perm_b32 v153, v158, v154, s62
  v_perm_b32 v158, v158, v154, s63
  v_perm_b32 v154, v159, v155, s62
  v_perm_b32 v159, v159, v155, s63
  v_perm_b32 v155, v172, v168, s62
  v_perm_b32 v172, v172, v168, s63
  v_perm_b32 v168, v173, v169, s62
  v_perm_b32 v173, v173, v169, s63
  v_perm_b32 v169, v174, v170, s62
  v_perm_b32 v174, v174, v170, s63
  v_perm_b32 v170, v175, v171, s62
  v_perm_b32 v175, v175, v171, s63
  s_waitcnt vmcnt(18)
  v_perm_b32 v171, v164, v160, s62
  v_perm_b32 v164, v164, v160, s63
  v_perm_b32 v160, v165, v161, s62
  v_perm_b32 v165, v165, v161, s63
  v_perm_b32 v161, v166, v162, s62
  v_perm_b32 v166, v166, v162, s63
  v_perm_b32 v162, v167, v163, s62
  v_perm_b32 v167, v167, v163, s63
  v_perm_b32 v163, v180, v176, s62
  v_perm_b32 v180, v180, v176, s63
  v_perm_b32 v176, v181, v177, s62
  v_perm_b32 v181, v181, v177, s63
  v_perm_b32 v177, v182, v178, s62
  v_perm_b32 v182, v182, v178, s63
  v_perm_b32 v178, v183, v179, s62
  v_perm_b32 v183, v183, v179, s63
  s_waitcnt vmcnt(8)
  s_branch L_hC_chk
L_Cnt:
  s_lshl_b32 s59, s66, 14
  buffer_load_dword v184, v203, s[28:31], s59 offen offset:0 nt
  buffer_load_dword v185, v203, s[28:31], s59 offen offset:1024 nt
  buffer_load_dword v186, v203, s[28:31], s59 offen offset:2048 nt
  buffer_load_dword v187, v203, s[28:31], s59 offen offset:3072 nt
  s_add_u32 s59, s59, 4096
  buffer_load_dword v188, v203, s[28:31], s59 offen offset:0 nt
  buffer_load_dword v189, v203, s[28:31], s59 offen offset:1024 nt
  buffer_load_dword v190, v203, s[28:31], s59 offen offset:2048 nt
  buffer_load_dword v191, v203, s[28:31], s59 offen offset:3072 nt
  s_add_u32 s59, s59, 4096
  buffer_load_dword v192, v203, s[28:31], s59 offen offset:0 nt
  buffer_load_dword v193, v203, s[28:31], s59 offen offset:1024 nt
  buffer_load_dword v194, v203, s[28:31], s59 offen offset:2048 nt
  buffer_load_dword v195, v203, s[28:31], s59 offen offset:3072 nt
  s_add_u32 s59, s59, 4096
  buffer_load_dword v196, v203, s[28:31], s59 offen offset:0 nt
  buffer_load_dword v197, v203, s[28:31], s59 offen offset:1024 nt
  buffer_load_dword v198, v203, s[28:31], s59 offen offset:2048 nt
  buffer_load_dword v199, v203, s[28:31], s59 offen offset:3072 nt
  s_waitcnt vmcnt(20)
  v_perm_b32 v200, v156, v152, s62
  v_perm_b32 v156, v156, v152, s63
  v_perm_b32 v152, v157, v153, s62
  v_perm_b32 v157, v157, v153, s63
  v_perm_b32 v153, v158, v154, s62
  v_perm_b32 v158, v158, v154, s63
  v_perm_b32 v154, v159, v155, s62
  v_perm_b32 v159, v159, v155, s63
  v_perm_b32 v155, v172, v168, s62
  v_perm_b32 v172, v172, v168, s63
  v_perm_b32 v168, v173, v169, s62
  v_perm_b32 v173, v173, v169, s63
  v_perm_b32 v169, v174, v170, s62
  v_perm_b32 v174, v174, v170, s63
  v_perm_b32 v170, v175, v171, s62
  v_perm_b32 v175, v175, v171, s63
  s_waitcnt vmcnt(16)
  v_perm_b32 v171, v164, v160, s62
  v_perm_b32 v164, v164, v160, s63
  v_perm_b32 v160, v165, v161, s62
  v_perm_b32 v165, v165, v161, s63
  v_perm_b32 v161, v166, v162, s62
  v_perm_b32 v166, v166, v162, s63
  v_perm_b32 v162, v167, v163, s62
  v_perm_b32 v167, v167, v163, s63
  v_perm_b32 v163, v180, v176, s62
  v_perm_b32 v180, v180, v176, s63
  v_perm_b32 v176, v181, v177, s62
  v_perm_b32 v181, v181, v177, s63
  v_perm_b32 v177, v182, v178, s62
  v_perm_b32 v182, v182, v178, s63
  v_perm_b32 v178, v183, v179, s62
  v_perm_b32 v183, v183, v179, s63
  s_branch L_Cpre
  s_mov_b32 s64, 200000
L_hC:
  buffer_load_dwordx4 v[40:43], v7, s[36:39], s72 offen sc1
  buffer_load_dwordx4 v[44:47], v7, s[36:39], s68 offen sc1
  s_waitcnt vmcnt(0)
L_hC_chk:
  v_xor_b32 v84, s56, v41
  v_bitop3_b32 v84, v84, v43, s56 bitop3:0xf6
  v_bitop3_b32 v84, v84, v45, s56 bitop3:0xf6
  v_bitop3_b32 v84, v84, v47, s56 bitop3:0xf6
  v_cmp_ne_u32 vcc, 0, v84
  s_cbranch_vccz L_hC_ok
  s_mov_b64 exec, vcc
  s_sub_u32 s64, s64, 1
  s_cmp_lg_u32 s64, 0
  s_cbranch_scc1 L_hC
L_hC_ok:
  s_mov_b64 exec, -1
  v_lshlrev_b32 v236, 16, v40
  v_and_b32 v237, 0xffff0000, v40
  v_lshlrev_b32 v238, 16, v42
  v_and_b32 v239, 0xffff0000, v42
  v_lshlrev_b32 v240, 16, v44
  v_and_b32 v241, 0xffff0000, v44
  v_lshlrev_b32 v242, 16, v46
  v_and_b32 v243, 0xffff0000, v46
  v_add_f32 v24, v236, v237
  v_mul_f32 v25, v236, v236
  v_add_f32 v26, v238, v239
  v_mul_f32 v27, v237, v237
  v_fmac_f32 v25, v238, v238
  v_fmac_f32 v27, v239, v239
  v_fmac_f32 v25, v240, v240
  v_add_f32 v24, v24, v240
  v_fmac_f32 v27, v241, v241
  v_add_f32 v26, v26, v241
  v_fmac_f32 v25, v242, v242
  v_add_f32 v24, v24, v242
  v_fmac_f32 v27, v243, v243
  v_add_f32 v26, v26, v243
  v_add_f32 v24, v24, v26
  v_add_f32 v25, v25, v27
  s_nop 1
  v_permlane32_swap_b32 v24, v25
  v_add_f32 v24, v24, v25
  s_nop 1
  v_add_f32_dpp v24, v24, v24 quad_perm:[1,0,3,2] row_mask:0xf bank_mask:0xf
  s_nop 1
  v_add_f32_dpp v24, v24, v24 quad_perm:[2,3,0,1] row_mask:0xf bank_mask:0xf
  s_nop 1
  v_add_f32_dpp v24, v24, v24 row_half_mirror row_mask:0xf bank_mask:0xf
  s_nop 1
  v_add_f32_dpp v24, v24, v24 row_mirror row_mask:0xf bank_mask:0xf
  v_mov_b32 v26, v24
  s_nop 1
  v_permlane16_swap_b32 v24, v26
  v_add_f32 v24, v24, v26
  v_mul_f32 v24, 0x3b000000, v24
  v_mov_b32 v25, v24
  s_nop 1
  v_permlane32_swap_b32 v24, v25
  v_fma_f32 v25, -v24, v24, v25
  v_max_f32 v25, 0, v25
  v_cvt_pk_bf16_f32 v26, v24, v25
  v_and_b32 v25, 0xffff0000, v26
  v_add_f32 v25, 0x3727c5ac, v25
  v_lshlrev_b32 v28, 16, v26
  v_cvt_pk_bf16_f32 v25, v25, v25
  v_lshlrev_b32 v25, 16, v25
  v_sqrt_f32 v25, v25
  v_sub_f32 v236, v236, v28
  v_sub_f32 v237, v237, v28
  v_cvt_pk_bf16_f32 v25, v25, v25
  v_lshlrev_b32 v25, 16, v25
  v_rcp_f32 v29, v25
  v_sub_f32 v238, v238, v28
  v_sub_f32 v239, v239, v28
  v_sub_f32 v240, v240, v28
  v_sub_f32 v241, v241, v28
  v_sub_f32 v242, v242, v28
  v_sub_f32 v243, v243, v28
  v_cvt_pk_bf16_f32 v48, v236, v237
  v_cvt_pk_bf16_f32 v49, v238, v239
  v_cvt_pk_bf16_f32 v50, v240, v241
  v_cvt_pk_bf16_f32 v51, v242, v243
  v_lshlrev_b32 v236, 16, v48
  v_and_b32 v237, 0xffff0000, v48
  v_lshlrev_b32 v238, 16, v49
  v_and_b32 v239, 0xffff0000, v49
  v_lshlrev_b32 v240, 16, v50
  v_and_b32 v241, 0xffff0000, v50
  v_lshlrev_b32 v242, 16, v51
  v_and_b32 v243, 0xffff0000, v51
  v_mul_f32 v236, v236, v29
  v_mul_f32 v237, v237, v29
  v_mul_f32 v238, v238, v29
  v_mul_f32 v239, v239, v29
  v_mul_f32 v240, v240, v29
  v_mul_f32 v241, v241, v29
  v_mul_f32 v242, v242, v29
  v_mul_f32 v243, v243, v29
  v_cvt_pk_bf16_f32 v48, v236, v237
  v_cvt_pk_bf16_f32 v49, v238, v239
  v_cvt_pk_bf16_f32 v50, v240, v241
  v_cvt_pk_bf16_f32 v51, v242, v243
  ds_write_b128 v211, v[48:51] offset:3072
L_Cpre:
  v_lshrrev_b32 v5, 1, v0
  v_lshlrev_b32 v5, 3, v5
  v_lshlrev_b32 v7, 2, v1
  v_lshlrev_b32 v6, 1, v203
  s_lshl_b32 s65, s66, 11
  s_add_u32 s65, s65, 1638400
  s_waitcnt lgkmcnt(0)
  s_barrier
  ds_read_b64 v[40:41], v5 offset:3072
  s_waitcnt lgkmcnt(0)
  v_dot2c_f32_bf16 v56, v200, v40
  v_dot2c_f32_bf16 v57, v156, v40
  v_dot2c_f32_bf16 v58, v152, v40
  v_dot2c_f32_bf16 v59, v157, v40
  v_dot2c_f32_bf16 v60, v153, v40
  v_dot2c_f32_bf16 v61, v158, v40
  v_dot2c_f32_bf16 v62, v154, v40
  v_dot2c_f32_bf16 v63, v159, v40
  v_dot2c_f32_bf16 v64, v155, v40
  v_dot2c_f32_bf16 v65, v172, v40
  v_dot2c_f32_bf16 v66, v168, v40
  v_dot2c_f32_bf16 v67, v173, v40
  v_dot2c_f32_bf16 v68, v169, v40
  v_dot2c_f32_bf16 v69, v174, v40
  v_dot2c_f32_bf16 v70, v170, v40
  v_dot2c_f32_bf16 v71, v175, v40
  v_dot2c_f32_bf16 v56, v171, v41
  v_dot2c_f32_bf16 v57, v164, v41
  v_dot2c_f32_bf16 v58, v160, v41
  v_dot2c_f32_bf16 v59, v165, v41
  v_dot2c_f32_bf16 v60, v161, v41
  v_dot2c_f32_bf16 v61, v166, v41
  v_dot2c_f32_bf16 v62, v162, v41
  v_dot2c_f32_bf16 v63, v167, v41
  v_dot2c_f32_bf16 v64, v163, v41
  v_dot2c_f32_bf16 v65, v180, v41
  v_dot2c_f32_bf16 v66, v176, v41
  v_dot2c_f32_bf16 v67, v181, v41
  v_dot2c_f32_bf16 v68, v177, v41
  v_dot2c_f32_bf16 v69, v182, v41
  v_dot2c_f32_bf16 v70, v178, v41
  v_dot2c_f32_bf16 v71, v183, v41
  v_permlane32_swap_b32 v56, v64
  v_permlane32_swap_b32 v57, v65
  v_permlane32_swap_b32 v58, v66
  v_permlane32_swap_b32 v59, v67
  v_permlane32_swap_b32 v60, v68
  v_permlane32_swap_b32 v61, v69
  v_permlane32_swap_b32 v62, v70
  v_permlane32_swap_b32 v63, v71
  v_add_f32 v56, v56, v64
  v_add_f32 v57, v57, v65
  v_add_f32 v58, v58, v66
  v_add_f32 v59, v59, v67
  v_add_f32 v60, v60, v68
  v_add_f32 v61, v61, v69
  v_add_f32 v62, v62, v70
  v_add_f32 v63, v63, v71
  v_permlane16_swap_b32 v56, v60
  v_permlane16_swap_b32 v57, v61
  v_permlane16_swap_b32 v58, v62
  v_permlane16_swap_b32 v59, v63
  v_add_f32 v56, v56, v60
  v_add_f32 v57, v57, v61
  v_add_f32 v58, v58, v62
  v_add_f32 v59, v59, v63
  v_add_f32_dpp v56, v56, v56 row_ror:8 row_mask:0xf bank_mask:0x3
  v_add_f32_dpp v57, v57, v57 row_ror:8 row_mask:0xf bank_mask:0x3
  s_nop 0
  v_add_f32_dpp v56, v58, v58 row_ror:8 row_mask:0xf bank_mask:0xc
  v_add_f32_dpp v57, v59, v59 row_ror:8 row_mask:0xf bank_mask:0xc
  s_nop 0
  v_add_f32_dpp v56, v56, v56 row_ror:12 row_mask:0xf bank_mask:0x5
  s_nop 1
  v_add_f32_dpp v56, v57, v57 row_ror:4 row_mask:0xf bank_mask:0xa
  s_nop 1
  v_add_f32_dpp v56, v56, v56 quad_perm:[2,3,0,1] row_mask:0xf bank_mask:0xf
  ds_write_b32 v203, v56 offset:0
  s_waitcnt lgkmcnt(0)
  s_barrier
  ds_read2st64_b32 v[72:73], v7 offset0:0 offset1:1
  ds_read2st64_b32 v[74:75], v7 offset0:2 offset1:3
  s_waitcnt vmcnt(0)
  v_perm_b32 v179, v185, v184, s62
  v_perm_b32 v185, v185, v184, s63
  v_perm_b32 v184, v187, v186, s62
  v_perm_b32 v187, v187, v186, s63
  v_perm_b32 v186, v189, v188, s62
  v_perm_b32 v189, v189, v188, s63
  v_perm_b32 v188, v191, v190, s62
  v_perm_b32 v191, v191, v190, s63
  v_perm_b32 v190, v193, v192, s62
  v_perm_b32 v193, v193, v192, s63
  v_perm_b32 v192, v195, v194, s62
  v_perm_b32 v195, v195, v194, s63
  v_perm_b32 v194, v197, v196, s62
  v_perm_b32 v197, v197, v196, s63
  v_perm_b32 v196, v199, v198, s62
  v_perm_b32 v199, v199, v198, s63
  s_waitcnt lgkmcnt(0)
  v_add_f32 v72, v72, v73
  v_add_f32 v74, v74, v75
  v_add_f32 v72, v72, v74
  v_cvt_pk_bf16_f32 v72, v72, v72
  v_lshlrev_b32 v72, 16, v72
  v_mov_b32 v73, v72
  s_nop 1
  v_permlane32_swap_b32 v72, v73
  v_max_f32 v72, 0, v72
  v_mul_f32 v72, v72, v73
  s_nop 1
  v_mov_b32_dpp v73, v72 row_ror:12 row_mask:0xf bank_mask:0xf
  v_cvt_pk_bf16_f32 v76, v72, v73
  s_nop 0
  v_readlane_b32 s40, v76, 0
  v_readlane_b32 s41, v76, 8
  v_readlane_b32 s42, v76, 16
  v_readlane_b32 s43, v76, 24
  v_readlane_b32 s44, v76, 1
  v_readlane_b32 s45, v76, 9
  v_readlane_b32 s46, v76, 17
  v_readlane_b32 s47, v76, 25
  v_dot2c_f32_bf16 v32, s40, v179
  v_dot2c_f32_bf16 v33, s40, v185
  v_dot2c_f32_bf16 v32, s41, v184
  v_dot2c_f32_bf16 v33, s41, v187
  v_dot2c_f32_bf16 v32, s42, v186
  v_dot2c_f32_bf16 v33, s42, v189
  v_dot2c_f32_bf16 v32, s43, v188
  v_dot2c_f32_bf16 v33, s43, v191
  v_dot2c_f32_bf16 v32, s44, v190
  v_dot2c_f32_bf16 v33, s44, v193
  v_dot2c_f32_bf16 v32, s45, v192
  v_dot2c_f32_bf16 v33, s45, v195
  v_dot2c_f32_bf16 v32, s46, v194
  v_dot2c_f32_bf16 v33, s46, v197
  v_dot2c_f32_bf16 v32, s47, v196
  v_dot2c_f32_bf16 v33, s47, v199
  s_nop 1
  v_and_or_b32 v32, v32, s70, v209
  v_and_or_b32 v33, v33, s70, v210
  buffer_store_dwordx2 v[32:33], v6, s[36:39], s65 offen sc1
  s_branch L_fin
L_finb:
  s_barrier
L_fin:
L_end:
  s_endpgm
.section .rodata,"a"
.p2align 6
.amdhsa_kernel sequential_preLN__gqa_block_cached__glu_gated_reglu__decode_kernel
  .amdhsa_next_free_vgpr 512
  .amdhsa_next_free_sgpr 102
  .amdhsa_accum_offset 256
  .amdhsa_group_segment_fixed_size 0
  .amdhsa_kernarg_size 96
  .amdhsa_user_sgpr_count 2
  .amdhsa_user_sgpr_kernarg_segment_ptr 1
  .amdhsa_system_sgpr_workgroup_id_x 1
.end_amdhsa_kernel
```
